```python
import torch

def _softmax(x, axis=-1):
    return torch.softmax(x, dim=axis)
def _gelu(x):
    return torch.nn.functional.gelu(x, approximate="tanh")
def _silu(x):
    return torch.nn.functional.silu(x)
def _sigmoid(x):
    return torch.sigmoid(x)
def _layernorm(x, axis=-1, eps=1e-5):
    m = x.mean(dim=axis, keepdim=True)
    v = x.var(dim=axis, keepdim=True, unbiased=False)
    return (x - m) / torch.sqrt(v + eps)
def _scatter_add(tgt, idx, src, axis=0):
    return tgt.clone().index_add_(axis, idx, src)
def _segment_sum(src, seg, n):
    out = torch.zeros((n,) + src.shape[1:], dtype=src.dtype)
    return out.index_add_(0, seg, src)
def _pad(x, pw):
    flat = tuple(v for pair in reversed(pw) for v in pair)
    return torch.nn.functional.pad(x, flat)

kernel_name = 'sequential_preLN__compressed_kv_cla__glu_gated_reglu__decode'

def setup_inputs():

    _w = (lambda a: (lambda t: t.to(torch.bfloat16) if t.is_floating_point() else t)(torch.as_tensor(a)))
    def _A_setup():
        B, H, Sq, Sk, D, M = 1, 32, 1, 4096, 128, 640
        Dc = 4 * D
        return {
            "x": _w((lambda *s: torch.randn(*s, dtype=torch.bfloat16) * 0.05)(B, Sq, M)),
            "c_kv": _w((lambda *s: torch.randn(*s, dtype=torch.bfloat16) * 0.8)(B, Sk, Dc)),
            "w_q": _w((lambda *s: torch.randn(*s, dtype=torch.bfloat16) * 1.6)(M, H, D) * (M ** -0.5)),
            "w_uk": _w((lambda *s: torch.randn(*s, dtype=torch.bfloat16) * 1.6)(Dc, H, D) * (Dc ** -0.5)),
            "w_uv": _w((lambda *s: torch.randn(*s, dtype=torch.bfloat16) * 0.8)(Dc, H, D) * (Dc ** -0.5)),
            "w_o": _w((lambda *s: torch.randn(*s, dtype=torch.bfloat16) * 0.8)(H, D, M) * ((H * D) ** -0.5)),
        }
    _A_in = _A_setup()

    def _B_setup():
        B, S, D, F = 1, 1, 640, 1728
        return {
            "x": _w((lambda *s: torch.randn(*s, dtype=torch.bfloat16) * 0.05)(B, S, D)),
            "W_gate": _w((lambda *s: torch.randn(*s, dtype=torch.bfloat16) * 0.4)(D, F) * (2.0 / D) ** 0.5),
            "W_up": _w((lambda *s: torch.randn(*s, dtype=torch.bfloat16) * 0.4)(D, F) * (2.0 / D) ** 0.5),
            "W_down": _w((lambda *s: torch.randn(*s, dtype=torch.bfloat16) * 0.4)(F, D) * (1.0 / F) ** 0.5),
        }
    _B_in = _B_setup()

    return {
        "A_x": _A_in["x"],
        "A_c_kv": _A_in["c_kv"],
        "A_w_q": _A_in["w_q"],
        "A_w_uk": _A_in["w_uk"],
        "A_w_uv": _A_in["w_uv"],
        "A_w_o": _A_in["w_o"],
        "B_x": _B_in["x"],
        "B_W_gate": _B_in["W_gate"],
        "B_W_up": _B_in["W_up"],
        "B_W_down": _B_in["W_down"],
    }

def reference(A_x, A_c_kv, A_w_q, A_w_uk, A_w_uv, A_w_o, B_x, B_W_gate, B_W_up, B_W_down):
    def _A_ref(x, c_kv, w_q, w_uk, w_uv, w_o):
        B, Sq, M = x.shape[0], x.shape[1], x.shape[2]
        Sk = c_kv.shape[1]
        H, D = w_q.shape[1], w_q.shape[2]
        q = torch.einsum("bqm,mhd->bhqd", x, w_q)
        k = torch.einsum("bkc,chd->bhkd", c_kv, w_uk)
        v = torch.einsum("bkc,chd->bhkd", c_kv, w_uv)
        scores = torch.einsum("bhqd,bhkd->bhqk", q, k) * (D ** -0.5)
        off = Sk - Sq
        qi = torch.arange(Sq)[:, None]
        kj = torch.arange(Sk)[None, :]
        cmask = kj <= (qi + off)
        scores = torch.where(cmask[None, None], scores, -1e9)
        p = _softmax(scores, axis=-1)
        ctx = torch.einsum("bhqk,bhkd->bhqd", p, v)
        return torch.einsum("bhqd,hdm->bqm", ctx, w_o)

    def _B_ref(x, W_gate, W_up, W_down):
        gate = torch.einsum("bsd,df->bsf", x, W_gate)
        up = torch.einsum("bsd,df->bsf", x, W_up)
        gate = gate * (lambda x, dt: x.to(dt))(gate > 0, gate.dtype)
        h = gate * up
        return torch.einsum("bsf,fd->bsd", h, W_down)

    x = A_x
    h = x + _A_ref(_layernorm(x, axis=-1), A_c_kv, A_w_q, A_w_uk, A_w_uv, A_w_o)
    h2 = h + _B_ref(_layernorm(h, axis=-1), B_W_gate, B_W_up, B_W_down)
    return h2
```

```asm
; @launch grid=(256,1,1) block=(512,1,1) lds=163840
.amdgcn_target "amdgcn-amd-amdhsa--gfx950"
.text
.globl sequential_preLN__compressed_kv_cla__glu_gated_reglu__decode_kernel
.p2align 8
.type sequential_preLN__compressed_kv_cla__glu_gated_reglu__decode_kernel,@function
sequential_preLN__compressed_kv_cla__glu_gated_reglu__decode_kernel:
L_kstart:
    s_cmp_ge_u32 s2, 256
    s_cbranch_scc1 L_end
    s_load_dwordx2 s[56:57], s[0:1], 16
    s_load_dwordx2 s[8:9], s[0:1], 96
    s_load_dwordx2 s[12:13], s[0:1], 0
    s_load_dwordx2 s[16:17], s[0:1], 8
    s_and_b32 s4, s2, 7
    s_lshr_b32 s5, s2, 3
    v_lshrrev_b32 v1, 6, v0
    v_and_b32 v0, 63, v0
    v_readfirstlane_b32 s3, v1
    v_lshlrev_b32 v6, 4, v0
    v_and_b32 v1, 15, v0
    v_lshrrev_b32 v2, 4, v0
    s_cmp_ge_u32 s5, 16
    s_cbranch_scc0 L_nA
    s_cmp_lt_u32 s5, 24
    s_cbranch_scc1 L_roleA
L_nA:
    v_lshlrev_b32 v10, 1, v2
    v_xor_b32 v10, v10, v1
    v_lshlrev_b32 v10, 4, v10
    v_lshl_add_u32 v10, v2, 13, v10
    s_and_b32 s37, s3, 2
    s_lshl_b32 s37, s37, 6
    v_xor_b32 v11, s37, v10
    s_lshl_b32 s36, s4, 2
    s_cmp_ge_u32 s5, 24
    s_cbranch_scc1 L_idsF
    s_lshr_b32 s44, s5, 2
    s_and_b32 s45, s5, 3
    s_mul_i32 s46, s45, 96
    s_branch L_ids
L_idsF:
    s_sub_u32 s44, s5, 24
    s_lshr_b32 s44, s44, 1
    s_and_b32 s46, s5, 1
    s_add_u32 s45, s46, 4
    s_lshl_b32 s46, s46, 7
    s_add_u32 s46, s46, 384
L_ids:
    s_add_u32 s44, s44, s36
    s_lshl_b32 s37, s46, 13
    s_lshl_b32 s38, s44, 8
    s_add_u32 s37, s37, s38
    s_lshl_b32 s50, s3, 15
    s_add_u32 s37, s37, s50
    s_lshl_b32 s39, s3, 10
    s_add_u32 s39, s39, 122880
    s_mov_b32 s58, 5242880
    s_mov_b32 s59, 0x20000
    s_mov_b32 s10, 3145728
    s_mov_b32 s11, 0x20000
    s_mov_b32 s14, 1280
    s_mov_b32 s15, 0x20000
    s_waitcnt lgkmcnt(0)
    s_cmp_lg_u32 s3, 7
    s_cbranch_scc1 L_nox
    v_lshlrev_b32 v7, 2, v0
    buffer_load_dwordx4 v[16:19], v6, s[12:15], 0 offen
    buffer_load_dword v20, v7, s[12:15], 0 offen offset:1024
L_nox:
    s_mov_b32 m0, s39
    s_nop 0
    buffer_load_dwordx4 v11, s[56:59], s37 offen nt lds
    s_add_u32 s37, s37, 262144
    s_add_u32 s39, s39, 8192
    s_mov_b32 m0, s39
    s_nop 0
    buffer_load_dwordx4 v11, s[56:59], s37 offen nt lds
    s_add_u32 s37, s37, 262144
    s_add_u32 s39, s39, 8192
    s_mov_b32 m0, s39
    s_nop 0
    buffer_load_dwordx4 v11, s[56:59], s37 offen nt lds
    s_add_u32 s37, s37, 262144
    s_add_u32 s39, s39, 8192
    s_cmp_lt_u32 s5, 24
    s_cbranch_scc1 L_wq3
    s_mov_b32 m0, s39
    s_nop 0
    buffer_load_dwordx4 v11, s[56:59], s37 offen nt lds
L_wq3:
    s_load_dword s6, s[8:9], 0
    v_mov_b32 v4, 0
    v_lshlrev_b32 v5, 4, v2
    s_mov_b32 s40, 0x00010001
    s_mov_b32 s41, 0x00010001
    s_cmp_ge_u32 s5, 24
    s_cbranch_scc1 L_pre_F
    s_load_dwordx2 s[20:21], s[0:1], 24
    s_load_dwordx2 s[24:25], s[0:1], 32
    s_load_dwordx2 s[28:29], s[0:1], 40
    s_load_dwordx2 s[32:33], s[0:1], 80
    s_lshl_b32 s37, s44, 2
    s_add_u32 s49, s37, s45
    v_mov_b32 v24, -1
    v_mov_b32 v25, -1
    v_mov_b32 v26, -1
    v_mov_b32 v27, -1
    s_lshl_b32 s52, s49, 13
    s_lshl_b32 s39, s3, 10
    s_add_u32 s52, s52, s39
    s_add_u32 s52, s52, 2097152
    s_cmp_lg_u32 s3, 6
    s_cbranch_scc1 L_W_noctxclean
    s_lshl_b32 s37, s49, 8
    s_add_u32 s37, s37, 98304
    v_lshlrev_b32 v7, 4, v1
    v_and_b32 v28, 1, v2
    v_mul_u32_u24 v28, 32768, v28
    v_add_u32 v7, v7, v28
    s_mov_b32 exec_hi, 0
    buffer_store_dwordx4 v[24:27], v7, s[8:11], s37 offen sc1
    s_mov_b64 exec, -1
L_W_noctxclean:
    s_sub_u32 s53, s5, 10
    s_cmp_ge_u32 s53, 5
    s_cbranch_scc1 L_W_noymclean
    s_lshl_b32 s53, s53, 3
    s_add_u32 s53, s53, s4
    s_sub_u32 s39, s3, 4
    s_cmp_ge_u32 s39, 2
    s_cbranch_scc1 L_W_noymclean
    s_lshl_b32 s37, s53, 11
    s_lshl_b32 s39, s39, 10
    s_add_u32 s37, s37, s39
    s_add_u32 s37, s37, 360448
    s_cmp_eq_u32 s3, 5
    s_cselect_b32 s39, 0xfffff000, 0
    s_mov_b32 exec_lo, 0
    s_mov_b32 exec_hi, s39
    v_mov_b32 v24, 0
    v_mov_b32 v25, 0
    v_mov_b32 v26, 0
    v_mov_b32 v27, 0
    s_mov_b64 exec, -1
    buffer_store_dwordx4 v[24:27], v6, s[8:11], s37 offen sc1
L_W_noymclean:
    s_cmp_lg_u32 s3, 3
    s_cbranch_scc1 L_nopf0
    s_getpc_b64 s[36:37]
L_pfbase0:
    s_and_b32 s39, s5, 7
    s_lshl_b32 s39, s39, 11
    s_add_u32 s36, s36, L_kstart-L_pfbase0
    s_addc_u32 s37, s37, -1
    v_add_u32 v7, s39, v6
    v_cmp_gt_u32 vcc, L_codeend-L_kstart-1040, v7
    s_nop 0
    s_and_saveexec_b64 s[38:39], vcc
    global_load_dwordx4 v[252:255], v7, s[36:37]
    global_load_dwordx4 v[252:255], v7, s[36:37] offset:1024
    s_mov_b64 exec, s[38:39]
L_nopf0:
    v_xor_b32 v12, 128, v10
    s_lshl_b32 s51, s45, 20
    s_lshl_b32 s38, s44, 8
    s_add_u32 s51, s51, s38
    s_lshl_b32 s37, s3, 17
    s_add_u32 s37, s37, s51
    s_add_u32 s51, s51, s50
    s_lshl_b32 s39, s3, 12
    s_add_u32 s39, s39, 32768
    s_mov_b32 s22, 4194304
    s_mov_b32 s23, 0x20000
    s_waitcnt lgkmcnt(0)
    s_mov_b32 m0, s39
    s_nop 0
    buffer_load_dwordx4 v10, s[20:23], s37 offen nt lds
    s_add_u32 s37, s37, 32768
    s_add_u32 s39, s39, 1024
    s_mov_b32 m0, s39
    s_nop 0
    buffer_load_dwordx4 v10, s[20:23], s37 offen nt lds
    s_add_u32 s37, s37, 32768
    s_add_u32 s39, s39, 1024
    s_mov_b32 m0, s39
    s_nop 0
    buffer_load_dwordx4 v12, s[20:23], s37 offen nt lds
    s_add_u32 s37, s37, 32768
    s_add_u32 s39, s39, 1024
    s_mov_b32 m0, s39
    s_nop 0
    buffer_load_dwordx4 v12, s[20:23], s37 offen nt lds
    s_branch L_ph1W
L_pre_F:
    s_cmp_lg_u32 s3, 3
    s_cbranch_scc1 L_nopf1
    s_getpc_b64 s[36:37]
L_pfbase1:
    s_and_b32 s39, s5, 7
    s_lshl_b32 s39, s39, 11
    s_add_u32 s36, s36, L_kstart-L_pfbase1
    s_addc_u32 s37, s37, -1
    v_add_u32 v7, s39, v6
    v_cmp_gt_u32 vcc, L_codeend-L_kstart-1040, v7
    s_nop 0
    s_and_saveexec_b64 s[38:39], vcc
    global_load_dwordx4 v[252:255], v7, s[36:37]
    global_load_dwordx4 v[252:255], v7, s[36:37] offset:1024
    s_mov_b64 exec, s[38:39]
L_nopf1:
    s_cmp_lg_u32 s3, 7
    s_cbranch_scc1 L_nostatsF
    s_waitcnt vmcnt(4)
    v_add_u32 v29, 155648, v6
    ds_write_b128 v29, v[16:19]
    v_lshlrev_b32 v30, 2, v0
    v_add_u32 v30, 156672, v30
    ds_write_b32 v30, v20
    v_lshlrev_b32 v32, 16, v16
    v_and_b32 v33, 0xffff0000, v16
    v_lshlrev_b32 v34, 16, v17
    v_and_b32 v35, 0xffff0000, v17
    v_lshlrev_b32 v36, 16, v18
    v_and_b32 v37, 0xffff0000, v18
    v_lshlrev_b32 v38, 16, v19
    v_and_b32 v39, 0xffff0000, v19
    v_lshlrev_b32 v40, 16, v20
    v_and_b32 v41, 0xffff0000, v20
    v_add_f32 v42, v32, v33
    v_add_f32 v42, v42, v34
    v_add_f32 v42, v42, v35
    v_add_f32 v42, v42, v36
    v_add_f32 v42, v42, v37
    v_add_f32 v42, v42, v38
    v_add_f32 v42, v42, v39
    v_add_f32 v42, v42, v40
    v_add_f32 v42, v42, v41
    s_nop 1
    v_add_f32_dpp v42, v42, v42 row_shr:1 row_mask:0xf bank_mask:0xf bound_ctrl:0
    s_nop 1
    v_add_f32_dpp v42, v42, v42 row_shr:2 row_mask:0xf bank_mask:0xf bound_ctrl:0
    s_nop 1
    v_add_f32_dpp v42, v42, v42 row_shr:4 row_mask:0xf bank_mask:0xf bound_ctrl:0
    s_nop 1
    v_add_f32_dpp v42, v42, v42 row_shr:8 row_mask:0xf bank_mask:0xf bound_ctrl:0
    s_nop 1
    v_add_f32_dpp v42, v42, v42 row_bcast:15 row_mask:0xa bank_mask:0xf
    s_nop 1
    v_add_f32_dpp v42, v42, v42 row_bcast:31 row_mask:0xc bank_mask:0xf
    s_nop 0
    v_readlane_b32 s54, v42, 63
    s_mov_b32 s39, 986500301
    s_nop 0
    v_mov_b32 v43, s54
    v_mul_f32 v43, s39, v43
    v_sub_f32 v32, v32, v43
    v_sub_f32 v33, v33, v43
    v_sub_f32 v34, v34, v43
    v_sub_f32 v35, v35, v43
    v_sub_f32 v36, v36, v43
    v_sub_f32 v37, v37, v43
    v_sub_f32 v38, v38, v43
    v_sub_f32 v39, v39, v43
    v_sub_f32 v40, v40, v43
    v_sub_f32 v41, v41, v43
    v_mul_f32 v42, v32, v32
    v_fmac_f32 v42, v33, v33
    v_fmac_f32 v42, v34, v34
    v_fmac_f32 v42, v35, v35
    v_fmac_f32 v42, v36, v36
    v_fmac_f32 v42, v37, v37
    v_fmac_f32 v42, v38, v38
    v_fmac_f32 v42, v39, v39
    v_fmac_f32 v42, v40, v40
    v_fmac_f32 v42, v41, v41
    s_nop 1
    v_add_f32_dpp v42, v42, v42 row_shr:1 row_mask:0xf bank_mask:0xf bound_ctrl:0
    s_nop 1
    v_add_f32_dpp v42, v42, v42 row_shr:2 row_mask:0xf bank_mask:0xf bound_ctrl:0
    s_nop 1
    v_add_f32_dpp v42, v42, v42 row_shr:4 row_mask:0xf bank_mask:0xf bound_ctrl:0
    s_nop 1
    v_add_f32_dpp v42, v42, v42 row_shr:8 row_mask:0xf bank_mask:0xf bound_ctrl:0
    s_nop 1
    v_add_f32_dpp v42, v42, v42 row_bcast:15 row_mask:0xa bank_mask:0xf
    s_nop 1
    v_add_f32_dpp v42, v42, v42 row_bcast:31 row_mask:0xc bank_mask:0xf
    s_nop 0
    v_readlane_b32 s54, v42, 63
    s_nop 1
    v_mov_b32 v44, s54
    v_mov_b32 v42, 925353388
    v_fmac_f32 v42, s39, v44
    v_rsq_f32 v33, v42
    v_mov_b32 v32, v43
    v_mul_f32 v33, 1040356334, v33
    v_mov_b32 v29, 156928
    s_mov_b64 exec, 1
    ds_write_b64 v29, v[32:33]
    s_mov_b64 exec, -1
L_nostatsF:
    v_lshrrev_b32 v29, 2, v1
    v_and_b32 v30, 1, v2
    v_lshl_or_b32 v30, v30, 2, v29
    v_lshlrev_b32 v30, 1, v30
    v_bfe_u32 v31, v1, 1, 1
    s_lshl_b32 s39, s3, 1
    v_add_u32 v31, s39, v31
    v_xor_b32 v28, v31, v30
    v_lshlrev_b32 v28, 4, v28
    v_and_b32 v30, 1, v1
    v_lshl_add_u32 v28, v30, 3, v28
    v_lshl_add_u32 v29, v2, 3, v29
    v_lshl_add_u32 v28, v29, 8, v28
    v_add_u32 v28, 122880, v28
    s_lshl_b32 s36, s46, 1
    s_add_u32 s36, s36, 155648
    v_add_u32 v48, s36, v5
    s_mov_b32 s37, 0x3f803f80
    v_mov_b32 v32, s37
    v_mov_b32 v33, s37
    v_mov_b32 v34, s37
    v_mov_b32 v35, s37
    v_mov_b32 v36, s37
    v_mov_b32 v37, s37
    v_mov_b32 v38, s37
    v_mov_b32 v39, s37
    v_mov_b32 v40, s37
    v_mov_b32 v41, s37
    v_mov_b32 v42, s37
    v_mov_b32 v43, s37
    v_mov_b32 v44, s37
    v_mov_b32 v45, s37
    v_mov_b32 v46, s37
    v_mov_b32 v47, s37
    s_waitcnt lgkmcnt(0)
    s_mul_i32 s6, s6, 0x9E3779B1
    s_add_u32 s6, s6, 0x7F4A7C15
    v_mov_b32 v3, s6
    s_lshl_b32 s37, s44, 3
    s_add_u32 s37, s37, s45
    s_lshl_b32 s37, s37, 10
    s_lshl_b32 s39, s3, 7
    s_add_u32 s37, s37, s39
    s_add_u32 s38, s37, 786432
    s_add_u32 s37, s37, 524288
    v_lshlrev_b32 v31, 3, v1
    s_waitcnt vmcnt(0) lgkmcnt(0)
    s_barrier
    ds_read_b64_tr_b16 v[52:53], v28 offset:0
    ds_read_b64_tr_b16 v[54:55], v28 offset:1024
    ds_read_b64_tr_b16 v[56:57], v28 offset:8192
    ds_read_b64_tr_b16 v[58:59], v28 offset:9216
    ds_read_b64_tr_b16 v[60:61], v28 offset:16384
    ds_read_b64_tr_b16 v[62:63], v28 offset:17408
    ds_read_b64_tr_b16 v[64:65], v28 offset:24576
    ds_read_b64_tr_b16 v[66:67], v28 offset:25600
    s_mov_b32 exec_lo, 0x55555555
    s_mov_b32 exec_hi, 0x55555555
    ds_read_b128 v[32:35], v48 offset:0
    ds_read_b128 v[36:39], v48 offset:64
    ds_read_b128 v[40:43], v48 offset:128
    ds_read_b128 v[44:47], v48 offset:192
    s_mov_b64 exec, -1
    v_mov_b32 v30, 156928
    ds_read_b64 v[50:51], v30
    s_waitcnt lgkmcnt(0)
    v_mfma_f32_16x16x32_bf16 v[68:71], v[32:35], v[52:55], 0
    v_mfma_f32_16x16x32_bf16 v[68:71], v[36:39], v[56:59], v[68:71]
    v_mfma_f32_16x16x32_bf16 v[68:71], v[40:43], v[60:63], v[68:71]
    v_mfma_f32_16x16x32_bf16 v[68:71], v[44:47], v[64:67], v[68:71]
    s_nop 7
    v_fma_f32 v72, -v50, v69, v68
    v_mul_f32 v72, v72, v51
    v_mov_b32 v73, s6
    s_mov_b64 exec, 0xffff
    buffer_store_dwordx2 v[72:73], v31, s[8:11], s38 offen
    buffer_store_dwordx2 v[72:73], v31, s[8:11], s37 offen sc1
    s_mov_b64 exec, -1
    s_branch L_roleF
L_ph1W:
    s_cmp_lg_u32 s3, 7
    s_cbranch_scc1 L_nostatsW
    s_waitcnt vmcnt(7)
    v_add_u32 v29, 155648, v6
    ds_write_b128 v29, v[16:19]
    v_lshlrev_b32 v30, 2, v0
    v_add_u32 v30, 156672, v30
    ds_write_b32 v30, v20
    v_lshlrev_b32 v32, 16, v16
    v_and_b32 v33, 0xffff0000, v16
    v_lshlrev_b32 v34, 16, v17
    v_and_b32 v35, 0xffff0000, v17
    v_lshlrev_b32 v36, 16, v18
    v_and_b32 v37, 0xffff0000, v18
    v_lshlrev_b32 v38, 16, v19
    v_and_b32 v39, 0xffff0000, v19
    v_lshlrev_b32 v40, 16, v20
    v_and_b32 v41, 0xffff0000, v20
    v_add_f32 v42, v32, v33
    v_add_f32 v42, v42, v34
    v_add_f32 v42, v42, v35
    v_add_f32 v42, v42, v36
    v_add_f32 v42, v42, v37
    v_add_f32 v42, v42, v38
    v_add_f32 v42, v42, v39
    v_add_f32 v42, v42, v40
    v_add_f32 v42, v42, v41
    s_nop 1
    v_add_f32_dpp v42, v42, v42 row_shr:1 row_mask:0xf bank_mask:0xf bound_ctrl:0
    s_nop 1
    v_add_f32_dpp v42, v42, v42 row_shr:2 row_mask:0xf bank_mask:0xf bound_ctrl:0
    s_nop 1
    v_add_f32_dpp v42, v42, v42 row_shr:4 row_mask:0xf bank_mask:0xf bound_ctrl:0
    s_nop 1
    v_add_f32_dpp v42, v42, v42 row_shr:8 row_mask:0xf bank_mask:0xf bound_ctrl:0
    s_nop 1
    v_add_f32_dpp v42, v42, v42 row_bcast:15 row_mask:0xa bank_mask:0xf
    s_nop 1
    v_add_f32_dpp v42, v42, v42 row_bcast:31 row_mask:0xc bank_mask:0xf
    s_nop 0
    v_readlane_b32 s54, v42, 63
    s_mov_b32 s39, 986500301
    s_nop 0
    v_mov_b32 v43, s54
    v_mul_f32 v43, s39, v43
    v_sub_f32 v32, v32, v43
    v_sub_f32 v33, v33, v43
    v_sub_f32 v34, v34, v43
    v_sub_f32 v35, v35, v43
    v_sub_f32 v36, v36, v43
    v_sub_f32 v37, v37, v43
    v_sub_f32 v38, v38, v43
    v_sub_f32 v39, v39, v43
    v_sub_f32 v40, v40, v43
    v_sub_f32 v41, v41, v43
    v_mul_f32 v42, v32, v32
    v_fmac_f32 v42, v33, v33
    v_fmac_f32 v42, v34, v34
    v_fmac_f32 v42, v35, v35
    v_fmac_f32 v42, v36, v36
    v_fmac_f32 v42, v37, v37
    v_fmac_f32 v42, v38, v38
    v_fmac_f32 v42, v39, v39
    v_fmac_f32 v42, v40, v40
    v_fmac_f32 v42, v41, v41
    s_nop 1
    v_add_f32_dpp v42, v42, v42 row_shr:1 row_mask:0xf bank_mask:0xf bound_ctrl:0
    s_nop 1
    v_add_f32_dpp v42, v42, v42 row_shr:2 row_mask:0xf bank_mask:0xf bound_ctrl:0
    s_nop 1
    v_add_f32_dpp v42, v42, v42 row_shr:4 row_mask:0xf bank_mask:0xf bound_ctrl:0
    s_nop 1
    v_add_f32_dpp v42, v42, v42 row_shr:8 row_mask:0xf bank_mask:0xf bound_ctrl:0
    s_nop 1
    v_add_f32_dpp v42, v42, v42 row_bcast:15 row_mask:0xa bank_mask:0xf
    s_nop 1
    v_add_f32_dpp v42, v42, v42 row_bcast:31 row_mask:0xc bank_mask:0xf
    s_nop 0
    v_readlane_b32 s54, v42, 63
    s_nop 1
    v_mov_b32 v44, s54
    v_mov_b32 v42, 925353388
    v_fmac_f32 v42, s39, v44
    v_rsq_f32 v33, v42
    v_mov_b32 v32, v43
    v_mul_f32 v33, 1040356334, v33
    v_mov_b32 v29, 156928
    s_mov_b64 exec, 1
    ds_write_b64 v29, v[32:33]
    s_mov_b64 exec, -1
L_nostatsW:
    v_lshrrev_b32 v29, 2, v1
    v_and_b32 v30, 1, v2
    v_lshl_or_b32 v30, v30, 2, v29
    v_lshlrev_b32 v30, 1, v30
    v_bfe_u32 v31, v1, 1, 1
    s_lshl_b32 s39, s3, 1
    v_add_u32 v31, s39, v31
    v_xor_b32 v28, v31, v30
    v_lshlrev_b32 v28, 4, v28
    v_and_b32 v30, 1, v1
    v_lshl_add_u32 v28, v30, 3, v28
    v_lshl_add_u32 v29, v2, 3, v29
    v_lshl_add_u32 v28, v29, 8, v28
    v_add_u32 v28, 122880, v28
    s_lshl_b32 s36, s46, 1
    s_add_u32 s36, s36, 155648
    v_add_u32 v44, s36, v5
    s_mov_b32 s37, 0x3f803f80
    v_mov_b32 v32, s37
    v_mov_b32 v33, s37
    v_mov_b32 v34, s37
    v_mov_b32 v35, s37
    v_mov_b32 v36, s37
    v_mov_b32 v37, s37
    v_mov_b32 v38, s37
    v_mov_b32 v39, s37
    v_mov_b32 v40, s37
    v_mov_b32 v41, s37
    v_mov_b32 v42, s37
    v_mov_b32 v43, s37
    s_waitcnt lgkmcnt(0)
    s_mul_i32 s6, s6, 0x9E3779B1
    s_add_u32 s6, s6, 0x7F4A7C15
    v_mov_b32 v3, s6
    v_and_b32 v29, 3, v1
    v_lshlrev_b32 v29, 1, v29
    v_bfe_u32 v30, v1, 3, 1
    v_lshl_or_b32 v29, v30, 3, v29
    s_lshl_b32 s39, s3, 12
    s_add_u32 s39, s39, 32768
    v_lshlrev_b32 v30, 8, v1
    v_add_u32 v30, s39, v30
    v_add_u32 v45, 0, v2
    v_xor_b32 v45, v45, v29
    v_lshl_add_u32 v48, v45, 4, v30
    v_add_u32 v45, 4, v2
    v_xor_b32 v45, v45, v29
    v_lshl_add_u32 v49, v45, 4, v30
    v_add_u32 v45, 8, v2
    v_xor_b32 v45, v45, v29
    v_lshl_add_u32 v50, v45, 4, v30
    v_add_u32 v45, 12, v2
    v_xor_b32 v45, v45, v29
    v_lshl_add_u32 v51, v45, 4, v30
    v_lshlrev_b32 v45, 2, v0
    s_mul_i32 s39, s3, 272
    s_add_u32 s39, s39, 98304
    v_add_u32 v45, s39, v45
    v_and_b32 v46, 7, v1
    v_mul_u32_u24 v46, 272, v46
    v_add_u32 v46, v46, v5
    v_add_u32 v46, 98304, v46
    v_lshrrev_b32 v47, 2, v0
    v_lshlrev_b32 v47, 16, v47
    v_and_b32 v52, 3, v0
    v_lshl_add_u32 v47, v52, 4, v47
    v_lshlrev_b32 v52, 6, v52
    s_lshl_b32 s61, s44, 11
    s_lshl_b32 s39, s45, 9
    s_add_u32 s61, s61, s39
    s_lshl_b32 s39, s3, 6
    s_add_u32 s61, s61, s39
    s_add_u32 s61, s61, 1048576
    s_lshl_b32 s37, s44, 3
    s_add_u32 s37, s37, s45
    s_lshl_b32 s37, s37, 10
    s_lshl_b32 s39, s3, 7
    s_add_u32 s37, s37, s39
    s_add_u32 s38, s37, 786432
    s_add_u32 s37, s37, 524288
    v_lshlrev_b32 v31, 3, v1
    s_waitcnt vmcnt(4) lgkmcnt(0)
    s_barrier
    ds_read_b64_tr_b16 v[56:57], v28 offset:0
    ds_read_b64_tr_b16 v[58:59], v28 offset:1024
    ds_read_b64_tr_b16 v[60:61], v28 offset:8192
    ds_read_b64_tr_b16 v[62:63], v28 offset:9216
    ds_read_b64_tr_b16 v[64:65], v28 offset:16384
    ds_read_b64_tr_b16 v[66:67], v28 offset:17408
    s_mov_b32 exec_lo, 0x55555555
    s_mov_b32 exec_hi, 0x55555555
    ds_read_b128 v[32:35], v44 offset:0
    ds_read_b128 v[36:39], v44 offset:64
    ds_read_b128 v[40:43], v44 offset:128
    s_mov_b64 exec, -1
    v_mov_b32 v30, 156928
    ds_read_b64 v[54:55], v30
    s_waitcnt lgkmcnt(0)
    v_mfma_f32_16x16x32_bf16 v[68:71], v[32:35], v[56:59], 0
    v_mfma_f32_16x16x32_bf16 v[68:71], v[36:39], v[60:63], v[68:71]
    v_mfma_f32_16x16x32_bf16 v[68:71], v[40:43], v[64:67], v[68:71]
    s_nop 7
    v_fma_f32 v72, -v54, v69, v68
    v_mul_f32 v72, v72, v55
    v_mov_b32 v73, s6
    s_mov_b64 exec, 0xffff
    buffer_store_dwordx2 v[72:73], v31, s[8:11], s38 offen
    buffer_store_dwordx2 v[72:73], v31, s[8:11], s37 offen sc1
    s_mov_b64 exec, -1
    s_mov_b32 s26, 4194304
    s_mov_b32 s27, 0x20000
    s_mov_b32 s30, 5242880
    s_mov_b32 s31, 0x20000
    s_mov_b32 s34, 1280
    s_mov_b32 s35, 0x20000
    s_cmp_lt_u32 s3, 6
    s_cbranch_scc1 L_W_nolc
    s_lshl_b32 s37, s49, 13
    s_sub_u32 s39, s3, 6
    s_lshl_b32 s39, s39, 12
    s_add_u32 s37, s37, s39
    s_add_u32 s37, s37, 2097152
    buffer_store_dwordx4 v[24:27], v6, s[8:11], s37 offen offset:0 sc1
    buffer_store_dwordx4 v[24:27], v6, s[8:11], s37 offen offset:1024 sc1
    buffer_store_dwordx4 v[24:27], v6, s[8:11], s37 offen offset:2048 sc1
    buffer_store_dwordx4 v[24:27], v6, s[8:11], s37 offen offset:3072 sc1
    s_waitcnt vmcnt(0)
L_W_nolc:
    s_waitcnt vmcnt(2)
    ds_read_b128 v[76:79], v48
    ds_read_b128 v[80:83], v49
    ds_read_b128 v[84:87], v50
    ds_read_b128 v[88:91], v51
    v_mov_b32 v32, 0
    s_cmp_ge_u32 s3, 6
    s_cbranch_scc1 L_W_x1skip
    s_lshl_b32 s37, s44, 13
    s_lshl_b32 s39, s3, 10
    s_add_u32 s37, s37, s39
    s_add_u32 s38, s37, 786432
    s_add_u32 s37, s37, 524288
    s_mov_b32 s48, 0
L_poll2:
    buffer_load_dwordx4 v[32:35], v6, s[8:11], s38 offen sc1
    s_waitcnt vmcnt(0)
    v_xor_b32 v8, s6, v33
    v_xor_b32 v9, s6, v35
    v_or_b32 v8, v8, v9
    v_cmp_ne_u32 vcc, 0, v8
    s_nop 0
    s_cmp_lg_u64 vcc, 0
    s_cbranch_scc0 L_polldone2
    s_add_u32 s48, s48, 1
    s_and_b32 s55, s48, 15
    s_cmp_lg_u32 s55, 15
    s_cbranch_scc1 L_poll2
    buffer_load_dwordx4 v[32:35], v6, s[8:11], s37 offen sc1
    s_waitcnt vmcnt(0)
    v_xor_b32 v8, s6, v33
    v_xor_b32 v9, s6, v35
    v_or_b32 v8, v8, v9
    v_cmp_ne_u32 vcc, 0, v8
    s_cmp_ge_u32 s48, 262144
    s_cbranch_scc1 L_polldone2
    s_cmp_lg_u64 vcc, 0
    s_cbranch_scc1 L_poll2
L_polldone2:
    v_cvt_pk_bf16_f32 v32, v32, v34
L_W_x1skip:
    ds_write_b32 v45, v32
    s_waitcnt lgkmcnt(0)
    s_barrier
    ds_read_b128 v[92:95], v46 offset:0
    ds_read_b128 v[96:99], v46 offset:64
    ds_read_b128 v[100:103], v46 offset:128
    ds_read_b128 v[104:107], v46 offset:192
    v_mov_b32 v74, 0
    v_mov_b32 v75, s6
    s_waitcnt lgkmcnt(3)
    v_mfma_f32_16x16x32_bf16 v[68:71], v[76:79], v[92:95], 0
    s_waitcnt lgkmcnt(2)
    v_mfma_f32_16x16x32_bf16 v[68:71], v[80:83], v[96:99], v[68:71]
    s_waitcnt lgkmcnt(1)
    v_mfma_f32_16x16x32_bf16 v[68:71], v[84:87], v[100:103], v[68:71]
    s_waitcnt lgkmcnt(0)
    v_mfma_f32_16x16x32_bf16 v[68:71], v[88:91], v[104:107], v[68:71]
    s_nop 7
    v_add_f32_dpp v68, v68, v68 quad_perm:[1,0,3,2] row_mask:0xf bank_mask:0xf
    v_add_f32_dpp v69, v69, v69 quad_perm:[1,0,3,2] row_mask:0xf bank_mask:0xf
    v_add_f32_dpp v70, v70, v70 quad_perm:[1,0,3,2] row_mask:0xf bank_mask:0xf
    v_add_f32_dpp v71, v71, v71 quad_perm:[1,0,3,2] row_mask:0xf bank_mask:0xf
    v_add_f32_dpp v68, v68, v68 quad_perm:[2,3,0,1] row_mask:0xf bank_mask:0xf
    v_add_f32_dpp v69, v69, v69 quad_perm:[2,3,0,1] row_mask:0xf bank_mask:0xf
    v_add_f32_dpp v70, v70, v70 quad_perm:[2,3,0,1] row_mask:0xf bank_mask:0xf
    v_add_f32_dpp v71, v71, v71 quad_perm:[2,3,0,1] row_mask:0xf bank_mask:0xf
    v_add_f32_dpp v68, v68, v68 row_half_mirror row_mask:0xf bank_mask:0xf
    v_add_f32_dpp v69, v69, v69 row_half_mirror row_mask:0xf bank_mask:0xf
    v_add_f32_dpp v70, v70, v70 row_half_mirror row_mask:0xf bank_mask:0xf
    v_add_f32_dpp v71, v71, v71 row_half_mirror row_mask:0xf bank_mask:0xf
    v_cvt_pk_bf16_f32 v72, v68, v69
    v_cvt_pk_bf16_f32 v73, v70, v71
    ds_bpermute_b32 v72, v52, v72
    ds_bpermute_b32 v73, v52, v73
    s_mov_b32 exec_hi, 0
    s_waitcnt lgkmcnt(0)
    buffer_store_dwordx4 v[72:75], v47, s[8:11], s61 offen sc1
    s_mov_b64 exec, -1
    s_barrier
    s_mov_b32 s37, s51
    s_lshl_b32 s39, s3, 10
    s_add_u32 s39, s39, 0
    s_mov_b32 m0, s39
    s_nop 0
    buffer_load_dwordx4 v11, s[24:27], s37 offen nt lds
    s_add_u32 s37, s37, 262144
    s_add_u32 s39, s39, 8192
    s_mov_b32 m0, s39
    s_nop 0
    buffer_load_dwordx4 v11, s[24:27], s37 offen nt lds
    s_add_u32 s37, s37, 262144
    s_add_u32 s39, s39, 8192
    s_mov_b32 m0, s39
    s_nop 0
    buffer_load_dwordx4 v11, s[24:27], s37 offen nt lds
    s_add_u32 s37, s37, 262144
    s_add_u32 s39, s39, 8192
    s_mov_b32 m0, s39
    s_nop 0
    buffer_load_dwordx4 v11, s[24:27], s37 offen nt lds
    s_cmp_ge_u32 s5, 10
    s_cbranch_scc1 L_W_nowo
    s_lshl_b32 s37, s4, 9
    s_lshl_b32 s39, s3, 6
    s_add_u32 s37, s37, s39
    s_mul_i32 s37, s37, 1280
    s_lshl_b32 s39, s5, 7
    s_add_u32 s37, s37, s39
    s_lshl_b32 s39, s3, 13
    s_add_u32 s39, s39, 32768
    v_lshrrev_b32 v29, 3, v0
    v_and_b32 v30, 2, v29
    v_and_b32 v31, 7, v0
    v_xor_b32 v30, v30, v31
    v_lshlrev_b32 v30, 4, v30
    v_mul_u32_u24 v29, 0x500, v29
    v_add_u32 v29, v29, v30
    v_xor_b32 v30, 64, v29
    s_mov_b32 m0, s39
    s_nop 0
    buffer_load_dwordx4 v29, s[28:31], s37 offen nt lds
    s_add_u32 s37, s37, 10240
    s_add_u32 s39, s39, 1024
    s_mov_b32 m0, s39
    s_nop 0
    buffer_load_dwordx4 v30, s[28:31], s37 offen nt lds
    s_add_u32 s37, s37, 10240
    s_add_u32 s39, s39, 1024
    s_mov_b32 m0, s39
    s_nop 0
    buffer_load_dwordx4 v29, s[28:31], s37 offen nt lds
    s_add_u32 s37, s37, 10240
    s_add_u32 s39, s39, 1024
    s_mov_b32 m0, s39
    s_nop 0
    buffer_load_dwordx4 v30, s[28:31], s37 offen nt lds
    s_add_u32 s37, s37, 10240
    s_add_u32 s39, s39, 1024
    s_mov_b32 m0, s39
    s_nop 0
    buffer_load_dwordx4 v29, s[28:31], s37 offen nt lds
    s_add_u32 s37, s37, 10240
    s_add_u32 s39, s39, 1024
    s_mov_b32 m0, s39
    s_nop 0
    buffer_load_dwordx4 v30, s[28:31], s37 offen nt lds
    s_add_u32 s37, s37, 10240
    s_add_u32 s39, s39, 1024
    s_mov_b32 m0, s39
    s_nop 0
    buffer_load_dwordx4 v29, s[28:31], s37 offen nt lds
    s_add_u32 s37, s37, 10240
    s_add_u32 s39, s39, 1024
    s_mov_b32 m0, s39
    s_nop 0
    buffer_load_dwordx4 v30, s[28:31], s37 offen nt lds
L_W_nowo:
    v_and_b32 v32, 31, v0
    v_lshlrev_b32 v32, 4, v32
    v_lshrrev_b32 v29, 2, v1
    v_lshl_add_u32 v33, v2, 3, v29
    s_lshl_b32 s37, s3, 6
    v_add_u32 v33, s37, v33
    v_lshlrev_b32 v33, 7, v33
    v_and_b32 v29, 2, v29
    v_and_b32 v30, 1, v2
    v_lshl_or_b32 v29, v30, 2, v29
    v_bfe_u32 v30, v1, 1, 1
    v_xor_b32 v29, v29, v30
    v_lshl_add_u32 v33, v29, 4, v33
    v_and_b32 v30, 1, v1
    v_lshl_add_u32 v33, v30, 3, v33
    v_add_u32 v33, 32768, v33
    v_lshrrev_b32 v29, 2, v1
    v_and_b32 v30, 1, v29
    v_lshlrev_b32 v30, 3, v30
    v_and_b32 v31, 1, v2
    v_lshl_or_b32 v30, v31, 2, v30
    v_bfe_u32 v31, v1, 1, 1
    s_lshl_b32 s39, s3, 1
    v_add_u32 v31, s39, v31
    v_xor_b32 v34, v31, v30
    v_lshlrev_b32 v34, 4, v34
    v_and_b32 v30, 1, v1
    v_lshl_add_u32 v34, v30, 3, v34
    v_lshlrev_b32 v29, 2, v29
    v_add_u32 v29, v29, v2
    v_lshl_add_u32 v34, v29, 9, v34
    v_xor_b32 v35, 32, v34
    v_add_u32 v35, 256, v35
    v_and_b32 v29, 7, v1
    v_mov_b32 v30, 0xffff
    v_mov_b32 v31, 0xffff0000
    v_cmp_eq_u32 vcc, 0, v29
    s_nop 1
    v_cndmask_b32 v40, v4, v30, vcc
    v_cmp_eq_u32 vcc, 1, v29
    s_nop 1
    v_cndmask_b32 v40, v40, v31, vcc
    v_cmp_eq_u32 vcc, 2, v29
    s_nop 1
    v_cndmask_b32 v41, v4, v30, vcc
    v_cmp_eq_u32 vcc, 3, v29
    s_nop 1
    v_cndmask_b32 v41, v41, v31, vcc
    v_cmp_eq_u32 vcc, 4, v29
    s_nop 1
    v_cndmask_b32 v42, v4, v30, vcc
    v_cmp_eq_u32 vcc, 5, v29
    s_nop 1
    v_cndmask_b32 v42, v42, v31, vcc
    v_cmp_eq_u32 vcc, 6, v29
    s_nop 1
    v_cndmask_b32 v43, v4, v30, vcc
    v_cmp_eq_u32 vcc, 7, v29
    s_nop 1
    v_cndmask_b32 v43, v43, v31, vcc
    s_lshl_b32 s39, s3, 4
    v_lshl_add_u32 v44, v2, 2, s39
    v_lshl_add_u32 v45, v2, 3, v1
    v_lshlrev_b32 v45, 3, v45
    s_mul_i32 s39, s3, 272
    s_add_u32 s39, s39, 100608
    v_add_u32 v45, s39, v45
    v_mul_u32_u24 v46, 272, v29
    v_add_u32 v46, v46, v5
    v_add_u32 v46, 100608, v46
    v_lshrrev_b32 v47, 1, v2
    v_lshlrev_b32 v47, 6, v47
    v_and_b32 v30, 1, v2
    v_lshl_add_u32 v47, v30, 3, v47
    s_lshl_b32 s60, s44, 10
    s_lshl_b32 s39, s3, 7
    s_add_u32 s60, s60, s39
    s_lshl_b32 s39, s45, 4
    s_add_u32 s60, s60, s39
    s_lshl_b32 s50, s44, 9
    s_add_u32 s50, s50, 65536
    s_waitcnt vmcnt(0)
    s_barrier
    ds_read_b64_tr_b16 v[76:77], v34 offset:0
    ds_read_b64_tr_b16 v[78:79], v35 offset:0
    ds_read_b64_tr_b16 v[80:81], v34 offset:8192
    ds_read_b64_tr_b16 v[82:83], v35 offset:8192
    ds_read_b64_tr_b16 v[84:85], v34 offset:16384
    ds_read_b64_tr_b16 v[86:87], v35 offset:16384
    ds_read_b64_tr_b16 v[88:89], v34 offset:24576
    ds_read_b64_tr_b16 v[90:91], v35 offset:24576
    s_cmp_lg_u32 s3, 0
    s_cbranch_scc1 L_W_nohm
    s_mov_b32 exec_hi, 0
    s_mov_b32 s48, 0
L_poll3:
    buffer_load_dwordx4 v[48:51], v32, s[8:11], s50 offen sc1
    s_waitcnt vmcnt(0)
    v_cmp_ne_u32 vcc, s6, v51
    s_add_u32 s48, s48, 1
    s_cmp_ge_u32 s48, 262144
    s_cbranch_scc1 L_polldone3
    s_cmp_lg_u64 vcc, 0
    s_cbranch_scc0 L_polldone3
    s_sleep 2
    s_branch L_poll3
L_polldone3:
    v_max_f32_dpp v53, v48, v48 quad_perm:[1,0,3,2] row_mask:0xf bank_mask:0xf
    s_nop 1
    v_max_f32_dpp v53, v53, v53 quad_perm:[2,3,0,1] row_mask:0xf bank_mask:0xf
    s_nop 1
    v_max_f32_dpp v53, v53, v53 row_half_mirror row_mask:0xf bank_mask:0xf
    s_nop 1
    v_max_f32_dpp v53, v53, v53 row_mirror row_mask:0xf bank_mask:0xf
    s_mov_b64 exec, -1
    v_mov_b32 v54, v53
    s_nop 1
    v_permlane16_swap_b32 v53, v54
    v_max_f32 v53, v53, v54
    s_mov_b32 exec_hi, 0
    v_sub_f32 v48, v48, v53
    v_exp_f32 v48, v48
    s_nop 0
    v_cvt_pk_bf16_f32 v50, v48, v48
    v_lshrrev_b32 v53, 2, v32
    v_add_u32 v53, 104832, v53
    ds_write_b32 v53, v50
    v_and_b32 v48, 0xffff0000, v50
    v_mul_f32 v55, v48, v49
    s_nop 1
    v_add_f32_dpp v55, v55, v55 quad_perm:[1,0,3,2] row_mask:0xf bank_mask:0xf
    s_nop 1
    v_add_f32_dpp v55, v55, v55 quad_perm:[2,3,0,1] row_mask:0xf bank_mask:0xf
    s_nop 1
    v_add_f32_dpp v55, v55, v55 row_half_mirror row_mask:0xf bank_mask:0xf
    s_nop 1
    v_add_f32_dpp v55, v55, v55 row_mirror row_mask:0xf bank_mask:0xf
    s_mov_b64 exec, -1
    v_mov_b32 v54, v55
    s_nop 1
    v_permlane16_swap_b32 v55, v54
    v_add_f32 v55, v55, v54
    v_rcp_f32 v55, v55
    v_mov_b32 v53, 104960
    s_mov_b64 exec, 1
    ds_write_b32 v53, v55
    s_mov_b64 exec, -1
L_W_nohm:
    s_waitcnt lgkmcnt(0)
    s_barrier
    buffer_load_dwordx4 v[60:63], v6, s[8:11], s52 offen sc1
    v_add_u32 v53, 104832, v44
    v_mov_b32 v54, 104960
    ds_read_b32 v53, v53
    ds_read_b32 v55, v54
    s_waitcnt lgkmcnt(0)
    v_and_b32 v56, v53, v40
    v_and_b32 v57, v53, v41
    v_and_b32 v58, v53, v42
    v_and_b32 v59, v53, v43
    s_waitcnt vmcnt(0)
    v_cmp_eq_u32 vcc, -1, v60
    s_nop 0
    s_cmp_lg_u64 vcc, 0
    s_cbranch_scc0 L_W_x3ok
    s_mov_b32 s48, 0
L_poll4:
    buffer_load_dwordx4 v[60:63], v6, s[8:11], s52 offen sc1
    s_waitcnt vmcnt(0)
    v_cmp_eq_u32 vcc, -1, v60
    s_add_u32 s48, s48, 1
    s_cmp_ge_u32 s48, 262144
    s_cbranch_scc1 L_polldone4
    s_cmp_lg_u64 vcc, 0
    s_cbranch_scc1 L_poll4
L_polldone4:
L_W_x3ok:
    v_mfma_f32_16x16x32_bf16 v[68:71], v[60:63], v[56:59], 0
    s_nop 7
    v_cvt_pk_bf16_f32 v72, v68, v69
    v_cvt_pk_bf16_f32 v73, v70, v71
    s_mov_b32 exec_lo, 0x00ff00ff
    s_mov_b32 exec_hi, 0x00ff00ff
    ds_write_b64 v45, v[72:73]
    s_mov_b64 exec, -1
    s_waitcnt lgkmcnt(0)
    s_barrier
    ds_read_b128 v[124:127], v46 offset:0
    ds_read_b128 v[128:131], v46 offset:64
    ds_read_b128 v[132:135], v46 offset:128
    ds_read_b128 v[136:139], v46 offset:192
    s_add_u32 s39, s60, 131072
    s_add_u32 s38, s60, 98304
    s_waitcnt lgkmcnt(3)
    v_mfma_f32_16x16x32_bf16 v[68:71], v[76:79], v[124:127], 0
    s_waitcnt lgkmcnt(2)
    v_mfma_f32_16x16x32_bf16 v[68:71], v[80:83], v[128:131], v[68:71]
    s_waitcnt lgkmcnt(1)
    v_mfma_f32_16x16x32_bf16 v[68:71], v[84:87], v[132:135], v[68:71]
    s_waitcnt lgkmcnt(0)
    v_mfma_f32_16x16x32_bf16 v[68:71], v[88:91], v[136:139], v[68:71]
    s_nop 7
    v_add_f32_dpp v68, v68, v68 quad_perm:[1,0,3,2] row_mask:0xf bank_mask:0xf
    v_add_f32_dpp v69, v69, v69 quad_perm:[1,0,3,2] row_mask:0xf bank_mask:0xf
    v_add_f32_dpp v70, v70, v70 quad_perm:[1,0,3,2] row_mask:0xf bank_mask:0xf
    v_add_f32_dpp v71, v71, v71 quad_perm:[1,0,3,2] row_mask:0xf bank_mask:0xf
    v_add_f32_dpp v68, v68, v68 quad_perm:[2,3,0,1] row_mask:0xf bank_mask:0xf
    v_add_f32_dpp v69, v69, v69 quad_perm:[2,3,0,1] row_mask:0xf bank_mask:0xf
    v_add_f32_dpp v70, v70, v70 quad_perm:[2,3,0,1] row_mask:0xf bank_mask:0xf
    v_add_f32_dpp v71, v71, v71 quad_perm:[2,3,0,1] row_mask:0xf bank_mask:0xf
    v_add_f32_dpp v68, v68, v68 row_half_mirror row_mask:0xf bank_mask:0xf
    v_add_f32_dpp v69, v69, v69 row_half_mirror row_mask:0xf bank_mask:0xf
    v_add_f32_dpp v70, v70, v70 row_half_mirror row_mask:0xf bank_mask:0xf
    v_add_f32_dpp v71, v71, v71 row_half_mirror row_mask:0xf bank_mask:0xf
    v_mul_f32 v68, v55, v68
    v_mul_f32 v69, v55, v69
    v_mul_f32 v70, v55, v70
    v_mul_f32 v71, v55, v71
    v_cvt_pk_bf16_f32 v72, v68, v69
    v_cvt_pk_bf16_f32 v73, v70, v71
    v_min_u32 v72, 0xfffffffe, v72
    s_mov_b64 exec, s[40:41]
    buffer_store_dwordx2 v[72:73], v47, s[8:11], s39 offen
    buffer_store_dwordx2 v[72:73], v47, s[8:11], s38 offen sc1
    s_mov_b64 exec, -1
    s_lshl_b32 s37, s4, 2
    s_lshr_b32 s39, s3, 1
    s_add_u32 s37, s37, s39
    s_lshl_b32 s37, s37, 10
    s_and_b32 s39, s3, 1
    s_lshl_b32 s39, s39, 9
    s_add_u32 s37, s37, s39
    s_add_u32 s38, s37, 131072
    s_add_u32 s37, s37, 98304
    s_cmp_ge_u32 s5, 10
    s_cbranch_scc1 L_W_final
    v_xor_b32 v29, 0, v33
    ds_read_b64_tr_b16 v[92:93], v29 offset:0
    ds_read_b64_tr_b16 v[94:95], v29 offset:512
    ds_read_b64_tr_b16 v[96:97], v29 offset:4096
    ds_read_b64_tr_b16 v[98:99], v29 offset:4608
    v_xor_b32 v29, 32, v33
    ds_read_b64_tr_b16 v[100:101], v29 offset:0
    ds_read_b64_tr_b16 v[102:103], v29 offset:512
    ds_read_b64_tr_b16 v[104:105], v29 offset:4096
    ds_read_b64_tr_b16 v[106:107], v29 offset:4608
    v_xor_b32 v29, 64, v33
    ds_read_b64_tr_b16 v[108:109], v29 offset:0
    ds_read_b64_tr_b16 v[110:111], v29 offset:512
    ds_read_b64_tr_b16 v[112:113], v29 offset:4096
    ds_read_b64_tr_b16 v[114:115], v29 offset:4608
    v_xor_b32 v29, 96, v33
    ds_read_b64_tr_b16 v[116:117], v29 offset:0
    ds_read_b64_tr_b16 v[118:119], v29 offset:512
    ds_read_b64_tr_b16 v[120:121], v29 offset:4096
    ds_read_b64_tr_b16 v[122:123], v29 offset:4608
    v_lshlrev_b32 v40, 4, v1
    v_lshl_add_u32 v40, v2, 6, v40
    s_lshl_b32 s39, s3, 8
    s_add_u32 s39, s39, 102784
    v_lshlrev_b32 v29, 2, v1
    v_add_u32 v29, s39, v29
    s_mov_b32 exec_lo, 0x000f000f
    s_mov_b32 exec_hi, 0x000f000f
    s_mov_b32 s48, 0
L_poll5:
    buffer_load_dwordx4 v[56:59], v40, s[8:11], s38 offen offset:0 sc1
    buffer_load_dwordx4 v[60:63], v40, s[8:11], s38 offen offset:256 sc1
    s_waitcnt vmcnt(0)
    v_max_u32 v8, v56, v58
    v_max3_u32 v8, v8, v60, v62
    v_cmp_eq_u32 vcc, -1, v8
    s_nop 0
    s_cmp_lg_u64 vcc, 0
    s_cbranch_scc0 L_polldone5
    s_add_u32 s48, s48, 1
    s_and_b32 s55, s48, 15
    s_cmp_lg_u32 s55, 15
    s_cbranch_scc1 L_poll5
    buffer_load_dwordx4 v[56:59], v40, s[8:11], s37 offen offset:0 sc1
    buffer_load_dwordx4 v[60:63], v40, s[8:11], s37 offen offset:256 sc1
    s_waitcnt vmcnt(0)
    v_max_u32 v8, v56, v58
    v_max3_u32 v8, v8, v60, v62
    v_cmp_eq_u32 vcc, -1, v8
    s_cmp_ge_u32 s48, 262144
    s_cbranch_scc1 L_polldone5
    s_cmp_lg_u64 vcc, 0
    s_cbranch_scc1 L_poll5
L_polldone5:
    s_mov_b64 exec, -1
    s_waitcnt lgkmcnt(0)
    v_mfma_f32_16x16x32_bf16 v[76:79], v[56:59], v[92:95], 0
    v_mfma_f32_16x16x32_bf16 v[76:79], v[60:63], v[96:99], v[76:79]
    v_mfma_f32_16x16x32_bf16 v[80:83], v[56:59], v[100:103], 0
    v_mfma_f32_16x16x32_bf16 v[80:83], v[60:63], v[104:107], v[80:83]
    v_mfma_f32_16x16x32_bf16 v[84:87], v[56:59], v[108:111], 0
    v_mfma_f32_16x16x32_bf16 v[84:87], v[60:63], v[112:115], v[84:87]
    v_mfma_f32_16x16x32_bf16 v[88:91], v[56:59], v[116:119], 0
    v_mfma_f32_16x16x32_bf16 v[88:91], v[60:63], v[120:123], v[88:91]
    s_nop 1
    v_add_f32 v76, v76, v77
    v_add_f32 v78, v78, v79
    v_add_f32 v76, v76, v78
    v_add_f32 v80, v80, v81
    v_add_f32 v82, v82, v83
    v_add_f32 v80, v80, v82
    v_add_f32 v84, v84, v85
    v_add_f32 v86, v86, v87
    v_add_f32 v84, v84, v86
    v_add_f32 v88, v88, v89
    v_add_f32 v90, v90, v91
    v_add_f32 v88, v88, v90
    s_mov_b64 exec, 0xffff
    ds_write_b32 v29, v76 offset:0
    ds_write_b32 v29, v80 offset:64
    ds_write_b32 v29, v84 offset:128
    ds_write_b32 v29, v88 offset:192
    s_mov_b64 exec, -1
    s_waitcnt lgkmcnt(0)
    s_barrier
    s_cmp_ge_u32 s3, 2
    s_cbranch_scc1 L_W_done
    v_lshrrev_b32 v29, 2, v0
    v_and_b32 v30, 3, v0
    v_lshlrev_b32 v31, 9, v30
    v_lshl_add_u32 v31, v29, 4, v31
    v_add_u32 v31, 102784, v31
    ds_read_b128 v[56:59], v31
    ds_read_b128 v[60:63], v31 offset:256
    v_mul_u32_u24 v31, 0x5000, v2
    v_lshl_add_u32 v31, v1, 4, v31
    v_lshlrev_b32 v30, 4, v1
    s_mul_i32 s37, s4, 2560
    s_lshl_b32 s39, s5, 8
    s_add_u32 s37, s37, s39
    s_mul_i32 s39, s3, 4*0x5000
    s_add_u32 s37, s37, s39
    s_add_u32 s37, s37, 163840
    v_mov_b32 v38, 0
    v_mov_b32 v39, s6
    s_waitcnt lgkmcnt(0)
    v_add_f32 v56, v56, v60
    v_add_f32 v57, v57, v61
    v_add_f32 v58, v58, v62
    v_add_f32 v59, v59, v63
    v_add_f32_dpp v56, v56, v56 quad_perm:[1,0,3,2] row_mask:0xf bank_mask:0xf
    v_add_f32_dpp v57, v57, v57 quad_perm:[1,0,3,2] row_mask:0xf bank_mask:0xf
    v_add_f32_dpp v58, v58, v58 quad_perm:[1,0,3,2] row_mask:0xf bank_mask:0xf
    v_add_f32_dpp v59, v59, v59 quad_perm:[1,0,3,2] row_mask:0xf bank_mask:0xf
    v_add_f32_dpp v56, v56, v56 quad_perm:[2,3,0,1] row_mask:0xf bank_mask:0xf
    v_add_f32_dpp v57, v57, v57 quad_perm:[2,3,0,1] row_mask:0xf bank_mask:0xf
    v_add_f32_dpp v58, v58, v58 quad_perm:[2,3,0,1] row_mask:0xf bank_mask:0xf
    v_add_f32_dpp v59, v59, v59 quad_perm:[2,3,0,1] row_mask:0xf bank_mask:0xf
    v_cvt_pk_bf16_f32 v36, v56, v57
    v_cvt_pk_bf16_f32 v37, v58, v59
    ds_bpermute_b32 v36, v30, v36
    ds_bpermute_b32 v37, v30, v37
    s_waitcnt lgkmcnt(0)
    buffer_store_dwordx4 v[36:39], v31, s[8:11], s37 offen sc1
    s_branch L_W_done
L_W_final:
    s_cmp_lg_u32 s3, 0
    s_cbranch_scc1 L_W_done
    s_cmp_ge_u32 s5, 15
    s_cbranch_scc1 L_W_done
    s_lshl_b32 s37, s53, 11
    s_add_u32 s37, s37, 360448
    v_mov_b32 v29, 0x3f80
    v_mov_b32 v30, 0x3f800000
    v_cmp_eq_u32 vcc, 0, v1
    s_nop 1
    v_cndmask_b32 v48, v4, v29, vcc
    v_cmp_eq_u32 vcc, 1, v1
    s_nop 1
    v_cndmask_b32 v48, v48, v30, vcc
    v_cmp_eq_u32 vcc, 2, v1
    s_nop 1
    v_cndmask_b32 v49, v4, v29, vcc
    v_cmp_eq_u32 vcc, 3, v1
    s_nop 1
    v_cndmask_b32 v49, v49, v30, vcc
    v_cmp_eq_u32 vcc, 4, v1
    s_nop 1
    v_cndmask_b32 v50, v4, v29, vcc
    v_cmp_eq_u32 vcc, 5, v1
    s_nop 1
    v_cndmask_b32 v50, v50, v30, vcc
    v_cmp_eq_u32 vcc, 6, v1
    s_nop 1
    v_cndmask_b32 v51, v4, v29, vcc
    v_cmp_eq_u32 vcc, 7, v1
    s_nop 1
    v_cndmask_b32 v51, v51, v30, vcc
    s_lshl_b32 s36, s53, 5
    v_mov_b32 v136, 0
    v_mov_b32 v137, 0
    v_mov_b32 v138, 0
    v_mov_b32 v139, 0
    v_and_b32 v31, 1, v0
    v_lshlrev_b32 v31, 4, v31
    s_mov_b64 exec, 0x30000
    buffer_load_dwordx4 v[136:139], v31, s[12:15], s36 offen
    s_mov_b64 exec, 0xffff
    v_lshrrev_b32 v29, 1, v1
    v_mul_u32_u24 v29, 2560, v29
    v_lshl_add_u32 v29, v31, 1, v29
    s_mul_i32 s38, s4, 0x5000
    s_lshl_b32 s39, s53, 6
    s_add_u32 s38, s38, s39
    s_add_u32 s38, s38, 163840
    s_mov_b32 s48, 0
L_poll6:
    buffer_load_dwordx4 v[140:143], v29, s[8:11], s38 offen sc1
    buffer_load_dwordx4 v[144:147], v29, s[8:11], s38 offen offset:16 sc1
    s_waitcnt vmcnt(0)
    v_xor_b32 v8, s6, v143
    v_xor_b32 v9, s6, v147
    v_or_b32 v8, v8, v9
    v_cmp_ne_u32 vcc, 0, v8
    s_add_u32 s48, s48, 1
    s_cmp_ge_u32 s48, 262144
    s_cbranch_scc1 L_polldone6
    s_cmp_lg_u64 vcc, 0
    s_cbranch_scc0 L_polldone6
    s_sleep 4
    s_branch L_poll6
L_polldone6:
    v_mov_b32 v136, v140
    v_mov_b32 v137, v141
    v_mov_b32 v138, v144
    v_mov_b32 v139, v145
    s_mov_b64 exec, -1
    s_nop 0
    v_mfma_f32_16x16x32_bf16 v[64:67], v[136:139], v[48:51], 0
    v_lshlrev_b32 v31, 1, v1
    s_mov_b32 s48, 0
L_poll7:
    buffer_load_dwordx4 v[124:127], v6, s[8:11], s37 offen sc1
    buffer_load_dwordx4 v[128:131], v6, s[8:11], s37 offen offset:1024 sc1
    s_waitcnt vmcnt(0)
    v_max_u32 v8, v124, v126
    v_max_u32 v8, v8, v128
    v_max_u32 v8, v8, v130
    v_cmp_eq_u32 vcc, -1, v8
    s_add_u32 s48, s48, 1
    s_cmp_ge_u32 s48, 262144
    s_cbranch_scc1 L_polldone7
    s_cmp_lg_u64 vcc, 0
    s_cbranch_scc0 L_polldone7
    s_sleep 1
    s_branch L_poll7
L_polldone7:
    v_mfma_f32_16x16x32_bf16 v[64:67], v[124:127], v[48:51], v[64:67]
    v_mfma_f32_16x16x32_bf16 v[64:67], v[128:131], v[48:51], v[64:67]
    s_nop 7
    v_add_f32 v64, v64, v66
    v_add_f32 v65, v65, v67
    v_mov_b32 v132, v64
    v_mov_b32 v133, v65
    s_nop 0
    v_permlane16_swap_b32 v64, v132
    v_permlane16_swap_b32 v65, v133
    v_add_f32 v64, v64, v132
    v_add_f32 v65, v65, v133
    v_mov_b32 v132, v64
    v_mov_b32 v133, v65
    s_nop 0
    v_permlane32_swap_b32 v64, v132
    v_permlane32_swap_b32 v65, v133
    v_add_f32 v64, v64, v132
    v_add_f32 v65, v65, v133
    s_nop 0
    v_mov_b32_dpp v132, v64 quad_perm:[1,1,3,3] row_mask:0xf bank_mask:0xf
    v_mov_b32_dpp v133, v65 quad_perm:[1,1,3,3] row_mask:0xf bank_mask:0xf
    v_cvt_pk_bf16_f32 v134, v64, v132
    v_cvt_pk_bf16_f32 v135, v65, v133
    s_mov_b64 exec, 0x55
    buffer_store_dword v134, v31, s[32:35], s36 offen
    buffer_store_dword v135, v31, s[32:35], s36 offen offset:16
    s_cmp_lg_u32 s53, 0
    s_cbranch_scc1 L_W_noep
    s_mov_b64 exec, 1
    v_mov_b32 v132, s6
    buffer_store_dword v132, v4, s[8:11], 0 offen offset:0
L_W_noep:
    s_mov_b64 exec, -1
L_W_done:
    s_endpgm
L_roleA:
    s_sub_u32 s36, s5, 16
    s_lshr_b32 s44, s36, 2
    s_and_b32 s36, s5, 3
    s_lshl_b32 s45, s4, 2
    s_add_u32 s45, s45, s36
    v_xor_b32 v20, 0, v6
    v_xor_b32 v21, 32, v6
    v_xor_b32 v22, 64, v6
    v_xor_b32 v23, 96, v6
    v_xor_b32 v24, 128, v6
    v_xor_b32 v25, 160, v6
    v_xor_b32 v26, 192, v6
    v_xor_b32 v27, 224, v6
    s_lshl_b32 s37, s45, 17
    s_lshl_b32 s39, s3, 14
    s_add_u32 s37, s37, s39
    s_mov_b32 s18, 4194304
    s_mov_b32 s19, 0x20000
    s_mov_b32 s10, 3145728
    s_mov_b32 s11, 0x20000
    s_waitcnt lgkmcnt(0)
    s_lshl_b32 s36, s44, 13
    s_add_u32 s37, s37, s36
    s_add_u32 s39, s39, s36
    s_lshl_b32 s36, s36, 1
    s_sub_u32 s38, 1024, s36
    s_mov_b32 m0, s39
    s_nop 0
    buffer_load_dwordx4 v20, s[16:19], s37 offen nt lds
    s_add_u32 s37, s37, 1024
    s_add_u32 s39, s39, 1024
    s_mov_b32 m0, s39
    s_nop 0
    buffer_load_dwordx4 v21, s[16:19], s37 offen nt lds
    s_add_u32 s37, s37, 1024
    s_add_u32 s39, s39, 1024
    s_mov_b32 m0, s39
    s_nop 0
    buffer_load_dwordx4 v22, s[16:19], s37 offen nt lds
    s_add_u32 s37, s37, 1024
    s_add_u32 s39, s39, 1024
    s_mov_b32 m0, s39
    s_nop 0
    buffer_load_dwordx4 v23, s[16:19], s37 offen nt lds
    s_add_u32 s37, s37, 1024
    s_add_u32 s39, s39, 1024
    s_mov_b32 m0, s39
    s_nop 0
    buffer_load_dwordx4 v24, s[16:19], s37 offen nt lds
    s_add_u32 s37, s37, 1024
    s_add_u32 s39, s39, 1024
    s_mov_b32 m0, s39
    s_nop 0
    buffer_load_dwordx4 v25, s[16:19], s37 offen nt lds
    s_add_u32 s37, s37, 1024
    s_add_u32 s39, s39, 1024
    s_mov_b32 m0, s39
    s_nop 0
    buffer_load_dwordx4 v26, s[16:19], s37 offen nt lds
    s_add_u32 s37, s37, 1024
    s_add_u32 s39, s39, 1024
    s_mov_b32 m0, s39
    s_nop 0
    buffer_load_dwordx4 v27, s[16:19], s37 offen nt lds
    s_add_u32 s37, s37, s38
    s_add_u32 s39, s39, s38
    s_mov_b32 m0, s39
    s_nop 0
    buffer_load_dwordx4 v20, s[16:19], s37 offen nt lds
    s_add_u32 s37, s37, 1024
    s_add_u32 s39, s39, 1024
    s_mov_b32 m0, s39
    s_nop 0
    buffer_load_dwordx4 v21, s[16:19], s37 offen nt lds
    s_add_u32 s37, s37, 1024
    s_add_u32 s39, s39, 1024
    s_mov_b32 m0, s39
    s_nop 0
    buffer_load_dwordx4 v22, s[16:19], s37 offen nt lds
    s_add_u32 s37, s37, 1024
    s_add_u32 s39, s39, 1024
    s_mov_b32 m0, s39
    s_nop 0
    buffer_load_dwordx4 v23, s[16:19], s37 offen nt lds
    s_add_u32 s37, s37, 1024
    s_add_u32 s39, s39, 1024
    s_mov_b32 m0, s39
    s_nop 0
    buffer_load_dwordx4 v24, s[16:19], s37 offen nt lds
    s_add_u32 s37, s37, 1024
    s_add_u32 s39, s39, 1024
    s_mov_b32 m0, s39
    s_nop 0
    buffer_load_dwordx4 v25, s[16:19], s37 offen nt lds
    s_add_u32 s37, s37, 1024
    s_add_u32 s39, s39, 1024
    s_mov_b32 m0, s39
    s_nop 0
    buffer_load_dwordx4 v26, s[16:19], s37 offen nt lds
    s_add_u32 s37, s37, 1024
    s_add_u32 s39, s39, 1024
    s_mov_b32 m0, s39
    s_nop 0
    buffer_load_dwordx4 v27, s[16:19], s37 offen nt lds
L_A_skipdma:
    s_load_dword s6, s[8:9], 0
    v_mov_b32 v4, 0
    v_lshlrev_b32 v5, 4, v2
    v_and_b32 v10, 7, v1
    v_lshlrev_b32 v10, 1, v10
    s_lshl_b32 s37, s3, 14
    v_lshlrev_b32 v11, 10, v1
    v_add_u32 v11, s37, v11
    v_add_u32 v12, 0, v2
    v_xor_b32 v12, v12, v10
    v_lshl_add_u32 v16, v12, 4, v11
    v_add_u32 v12, 4, v2
    v_xor_b32 v12, v12, v10
    v_lshl_add_u32 v17, v12, 4, v11
    v_add_u32 v12, 8, v2
    v_xor_b32 v12, v12, v10
    v_lshl_add_u32 v18, v12, 4, v11
    v_add_u32 v12, 12, v2
    v_xor_b32 v12, v12, v10
    v_lshl_add_u32 v19, v12, 4, v11
    v_lshrrev_b32 v10, 2, v1
    v_and_b32 v11, 1, v2
    v_lshl_add_u32 v11, v11, 2, v10
    v_lshlrev_b32 v11, 1, v11
    v_lshl_add_u32 v10, v2, 2, v10
    v_lshlrev_b32 v10, 10, v10
    v_and_b32 v12, 1, v1
    v_lshl_add_u32 v10, v12, 3, v10
    v_bfe_u32 v13, v1, 1, 1
    s_lshl_b32 s37, s3, 3
    v_add_u32 v13, s37, v13
    v_add_u32 v14, 0, v13
    v_xor_b32 v14, v14, v11
    v_lshl_add_u32 v20, v14, 4, v10
    v_add_u32 v14, 2, v13
    v_xor_b32 v14, v14, v11
    v_lshl_add_u32 v21, v14, 4, v10
    v_add_u32 v14, 4, v13
    v_xor_b32 v14, v14, v11
    v_lshl_add_u32 v22, v14, 4, v10
    v_add_u32 v14, 6, v13
    v_xor_b32 v14, v14, v11
    v_lshl_add_u32 v23, v14, 4, v10
    s_mul_i32 s37, s3, 2080
    s_add_u32 s37, s37, 131072
    v_lshlrev_b32 v13, 3, v0
    v_add_u32 v13, s37, v13
    v_mul_u32_u24 v14, 1040, v1
    v_add_u32 v14, v14, v5
    v_add_u32 v14, 131072, v14
    s_mul_i32 s37, s3, 2304
    v_mul_u32_u24 v15, 144, v1
    v_lshl_add_u32 v15, v2, 3, v15
    v_add_u32 v15, s37, v15
    v_lshrrev_b32 v24, 3, v0
    v_lshlrev_b32 v25, 15, v24
    v_mul_u32_u24 v24, 144, v24
    v_and_b32 v11, 7, v0
    v_lshl_add_u32 v24, v11, 4, v24
    v_add_u32 v24, s37, v24
    v_lshl_add_u32 v25, v11, 4, v25
    v_lshlrev_b32 v26, 5, v1
    v_add_u32 v27, 147712, v26
    s_lshl_b32 s37, s3, 2
    v_add_u32 v26, s37, v27
    s_lshr_b32 s37, s3, 1
    s_lshl_b32 s37, s37, 10
    s_and_b32 s39, s3, 1
    s_lshl_b32 s39, s39, 3
    s_add_u32 s37, s37, s39
    s_add_u32 s37, s37, 148736
    v_add_u32 v28, s37, v6
    v_add_u32 v29, 148736, v6
    v_lshlrev_b32 v30, 9, v1
    s_lshl_b32 s49, s44, 13
    s_lshl_b32 s39, s45, 4
    s_add_u32 s49, s49, s39
    s_add_u32 s49, s49, 65536
    s_lshl_b32 s50, s44, 6
    s_lshr_b32 s39, s3, 1
    s_add_u32 s50, s50, s39
    s_lshl_b32 s50, s50, 13
    s_lshl_b32 s39, s45, 8
    s_add_u32 s50, s50, s39
    s_and_b32 s39, s3, 1
    s_lshl_b32 s39, s39, 7
    s_add_u32 s50, s50, s39
    s_add_u32 s50, s50, 2097152
    s_add_u32 s51, s50, 262144
    s_lshl_b32 s52, s4, 16
    s_lshl_b32 s39, s44, 15
    s_add_u32 s52, s52, s39
    s_add_u32 s52, s52, 1048576
    s_waitcnt lgkmcnt(0)
    s_mul_i32 s6, s6, 0x9E3779B1
    s_add_u32 s6, s6, 0x7F4A7C15
    v_mov_b32 v3, s6
    s_cmp_lg_u32 s3, 3
    s_cbranch_scc1 L_nopf8
    s_getpc_b64 s[36:37]
L_pfbase8:
    s_and_b32 s39, s5, 7
    s_lshl_b32 s39, s39, 11
    s_add_u32 s36, s36, L_kstart-L_pfbase8
    s_addc_u32 s37, s37, -1
    v_add_u32 v7, s39, v6
    v_cmp_gt_u32 vcc, L_codeend-L_kstart-1040, v7
    s_nop 0
    s_and_saveexec_b64 s[38:39], vcc
    global_load_dwordx4 v[252:255], v7, s[36:37]
    global_load_dwordx4 v[252:255], v7, s[36:37] offset:1024
    s_mov_b64 exec, s[38:39]
L_nopf8:
    s_lshl_b32 s39, s3, 12
    s_add_u32 s37, s52, s39
    s_waitcnt vmcnt(0)
    s_barrier
    s_cmp_lg_u32 s3, 0
    s_cbranch_scc1 L_A_nohint1
    s_and_b32 s36, s45, 15
    s_lshl_b32 s36, s36, 11
    s_lshr_b32 s39, s45, 3
    s_lshl_b32 s39, s39, 9
    s_add_u32 s36, s36, s39
    s_add_u32 s36, s36, s52
    s_mov_b64 exec, 1
    buffer_load_dwordx4 v[224:227], v4, s[8:11], s36 offen sc1
    s_mov_b64 exec, -1
L_A_nohint1:
    ds_read_b128 v[32:35], v16 offset:0
    ds_read_b128 v[36:39], v17 offset:0
    ds_read_b128 v[40:43], v18 offset:0
    ds_read_b128 v[44:47], v19 offset:0
    ds_read_b128 v[48:51], v16 offset:256
    ds_read_b128 v[52:55], v17 offset:256
    ds_read_b128 v[56:59], v18 offset:256
    ds_read_b128 v[60:63], v19 offset:256
    ds_read_b128 v[64:67], v16 offset:512
    ds_read_b128 v[68:71], v17 offset:512
    ds_read_b128 v[72:75], v18 offset:512
    ds_read_b128 v[76:79], v19 offset:512
    ds_read_b128 v[80:83], v16 offset:768
    ds_read_b128 v[84:87], v17 offset:768
    ds_read_b128 v[88:91], v18 offset:768
    ds_read_b128 v[92:95], v19 offset:768
    s_cmp_lg_u32 s3, 0
    s_cbranch_scc1 L_A_nohint
    s_and_b32 s36, s45, 15
    s_lshl_b32 s36, s36, 11
    s_lshr_b32 s39, s45, 3
    s_lshl_b32 s39, s39, 9
    s_add_u32 s36, s36, s39
    s_add_u32 s36, s36, s52
    s_mov_b64 exec, 1
    s_waitcnt vmcnt(0)
    v_cmp_ne_u32 vcc, s6, v227
    s_nop 0
    s_cmp_lg_u64 vcc, 0
    s_cbranch_scc0 L_A_hintok
    s_mov_b32 s48, 0
L_poll9:
    buffer_load_dwordx4 v[224:227], v4, s[8:11], s36 offen sc1
    s_waitcnt vmcnt(0)
    v_cmp_ne_u32 vcc, s6, v227
    s_add_u32 s48, s48, 1
    s_cmp_ge_u32 s48, 262144
    s_cbranch_scc1 L_polldone9
    s_cmp_lg_u64 vcc, 0
    s_cbranch_scc0 L_polldone9
    s_sleep 2
    s_branch L_poll9
L_polldone9:
L_A_hintok:
    s_mov_b64 exec, -1
L_A_nohint:
    s_barrier
    buffer_load_dwordx4 v[224:227], v6, s[8:11], s37 offen offset:0 sc1
    buffer_load_dwordx4 v[228:231], v6, s[8:11], s37 offen offset:1024 sc1
    buffer_load_dwordx4 v[232:235], v6, s[8:11], s37 offen offset:2048 sc1
    buffer_load_dwordx4 v[236:239], v6, s[8:11], s37 offen offset:3072 sc1
    ds_read_b64_tr_b16 v[96:97], v20 offset:0
    ds_read_b64_tr_b16 v[98:99], v20 offset:16384
    ds_read_b64_tr_b16 v[100:101], v20 offset:32768
    ds_read_b64_tr_b16 v[102:103], v20 offset:49152
    ds_read_b64_tr_b16 v[112:113], v21 offset:0
    ds_read_b64_tr_b16 v[114:115], v21 offset:16384
    ds_read_b64_tr_b16 v[116:117], v21 offset:32768
    ds_read_b64_tr_b16 v[118:119], v21 offset:49152
    ds_read_b64_tr_b16 v[128:129], v22 offset:0
    ds_read_b64_tr_b16 v[130:131], v22 offset:16384
    ds_read_b64_tr_b16 v[132:133], v22 offset:32768
    ds_read_b64_tr_b16 v[134:135], v22 offset:49152
    ds_read_b64_tr_b16 v[144:145], v23 offset:0
    ds_read_b64_tr_b16 v[146:147], v23 offset:16384
    ds_read_b64_tr_b16 v[148:149], v23 offset:32768
    ds_read_b64_tr_b16 v[150:151], v23 offset:49152
    v_add_u32 v20, 0x10000, v20
    v_add_u32 v21, 0x10000, v21
    v_add_u32 v22, 0x10000, v22
    v_add_u32 v23, 0x10000, v23
    ds_read_b64_tr_b16 v[104:105], v20 offset:0
    ds_read_b64_tr_b16 v[106:107], v20 offset:16384
    ds_read_b64_tr_b16 v[108:109], v20 offset:32768
    ds_read_b64_tr_b16 v[110:111], v20 offset:49152
    ds_read_b64_tr_b16 v[120:121], v21 offset:0
    ds_read_b64_tr_b16 v[122:123], v21 offset:16384
    ds_read_b64_tr_b16 v[124:125], v21 offset:32768
    ds_read_b64_tr_b16 v[126:127], v21 offset:49152
    ds_read_b64_tr_b16 v[136:137], v22 offset:0
    ds_read_b64_tr_b16 v[138:139], v22 offset:16384
    ds_read_b64_tr_b16 v[140:141], v22 offset:32768
    ds_read_b64_tr_b16 v[142:143], v22 offset:49152
    ds_read_b64_tr_b16 v[152:153], v23 offset:0
    ds_read_b64_tr_b16 v[154:155], v23 offset:16384
    ds_read_b64_tr_b16 v[156:157], v23 offset:32768
    ds_read_b64_tr_b16 v[158:159], v23 offset:49152
    s_waitcnt vmcnt(0)
    v_xor_b32 v8, s6, v227
    v_xor_b32 v9, s6, v231
    v_or_b32 v8, v8, v9
    v_xor_b32 v9, s6, v235
    v_or_b32 v8, v8, v9
    v_xor_b32 v9, s6, v239
    v_or_b32 v8, v8, v9
    v_cmp_ne_u32 vcc, 0, v8
    s_nop 0
    s_cmp_lg_u64 vcc, 0
    s_cbranch_scc0 L_A_qaok2
    s_mov_b32 s48, 0
L_poll10:
    buffer_load_dwordx4 v[224:227], v6, s[8:11], s37 offen offset:0 sc1
    buffer_load_dwordx4 v[228:231], v6, s[8:11], s37 offen offset:1024 sc1
    buffer_load_dwordx4 v[232:235], v6, s[8:11], s37 offen offset:2048 sc1
    buffer_load_dwordx4 v[236:239], v6, s[8:11], s37 offen offset:3072 sc1
    s_waitcnt vmcnt(0)
    v_xor_b32 v8, s6, v227
    v_xor_b32 v9, s6, v231
    v_or_b32 v8, v8, v9
    v_xor_b32 v9, s6, v235
    v_or_b32 v8, v8, v9
    v_xor_b32 v9, s6, v239
    v_or_b32 v8, v8, v9
    v_cmp_ne_u32 vcc, 0, v8
    s_add_u32 s48, s48, 1
    s_cmp_ge_u32 s48, 262144
    s_cbranch_scc1 L_polldone10
    s_cmp_lg_u64 vcc, 0
    s_cbranch_scc1 L_poll10
L_polldone10:
L_A_qaok2:
    ds_write_b64 v13, v[224:225] offset:0
    ds_write_b64 v13, v[228:229] offset:512
    ds_write_b64 v13, v[232:233] offset:1040
    ds_write_b64 v13, v[236:237] offset:1552
    s_waitcnt lgkmcnt(0)
    s_barrier
    ds_read_b128 v[160:163], v14 offset:0
    ds_read_b128 v[164:167], v14 offset:64
    ds_read_b128 v[168:171], v14 offset:128
    ds_read_b128 v[172:175], v14 offset:192
    ds_read_b128 v[176:179], v14 offset:256
    ds_read_b128 v[180:183], v14 offset:320
    ds_read_b128 v[184:187], v14 offset:384
    ds_read_b128 v[188:191], v14 offset:448
    ds_read_b128 v[192:195], v14 offset:512
    ds_read_b128 v[196:199], v14 offset:576
    ds_read_b128 v[200:203], v14 offset:640
    ds_read_b128 v[204:207], v14 offset:704
    ds_read_b128 v[208:211], v14 offset:768
    ds_read_b128 v[212:215], v14 offset:832
    ds_read_b128 v[216:219], v14 offset:896
    ds_read_b128 v[220:223], v14 offset:960
    s_waitcnt lgkmcnt(15)
    v_mfma_f32_16x16x32_bf16 v[16:19], v[32:35], v[160:163], 0
    s_waitcnt lgkmcnt(14)
    v_mfma_f32_16x16x32_bf16 v[16:19], v[36:39], v[164:167], v[16:19]
    s_waitcnt lgkmcnt(13)
    v_mfma_f32_16x16x32_bf16 v[16:19], v[40:43], v[168:171], v[16:19]
    s_waitcnt lgkmcnt(12)
    v_mfma_f32_16x16x32_bf16 v[16:19], v[44:47], v[172:175], v[16:19]
    s_waitcnt lgkmcnt(11)
    v_mfma_f32_16x16x32_bf16 v[16:19], v[48:51], v[176:179], v[16:19]
    s_waitcnt lgkmcnt(10)
    v_mfma_f32_16x16x32_bf16 v[16:19], v[52:55], v[180:183], v[16:19]
    s_waitcnt lgkmcnt(9)
    v_mfma_f32_16x16x32_bf16 v[16:19], v[56:59], v[184:187], v[16:19]
    s_waitcnt lgkmcnt(8)
    v_mfma_f32_16x16x32_bf16 v[16:19], v[60:63], v[188:191], v[16:19]
    s_waitcnt lgkmcnt(7)
    v_mfma_f32_16x16x32_bf16 v[16:19], v[64:67], v[192:195], v[16:19]
    s_waitcnt lgkmcnt(6)
    v_mfma_f32_16x16x32_bf16 v[16:19], v[68:71], v[196:199], v[16:19]
    s_waitcnt lgkmcnt(5)
    v_mfma_f32_16x16x32_bf16 v[16:19], v[72:75], v[200:203], v[16:19]
    s_waitcnt lgkmcnt(4)
    v_mfma_f32_16x16x32_bf16 v[16:19], v[76:79], v[204:207], v[16:19]
    s_waitcnt lgkmcnt(3)
    v_mfma_f32_16x16x32_bf16 v[16:19], v[80:83], v[208:211], v[16:19]
    s_waitcnt lgkmcnt(2)
    v_mfma_f32_16x16x32_bf16 v[16:19], v[84:87], v[212:215], v[16:19]
    s_waitcnt lgkmcnt(1)
    v_mfma_f32_16x16x32_bf16 v[16:19], v[88:91], v[216:219], v[16:19]
    s_waitcnt lgkmcnt(0)
    v_mfma_f32_16x16x32_bf16 v[16:19], v[92:95], v[220:223], v[16:19]
    s_nop 7
    v_max_f32 v20, v16, v17
    v_max3_f32 v20, v20, v18, v19
    v_mov_b32 v21, v20
    s_nop 1
    v_permlane32_swap_b32 v20, v21
    v_max_f32 v20, v20, v21
    v_mov_b32 v21, v20
    s_nop 1
    v_permlane16_swap_b32 v20, v21
    v_max_f32 v20, v20, v21
    s_mov_b64 exec, 0xffff
    ds_write_b32 v26, v20
    s_mov_b64 exec, -1
    s_waitcnt lgkmcnt(0)
    s_barrier
    ds_read_b128 v[224:227], v27
    ds_read_b128 v[228:231], v27 offset:16
    s_waitcnt lgkmcnt(0)
    v_max3_f32 v20, v224, v225, v226
    v_max3_f32 v21, v227, v228, v229
    v_max3_f32 v20, v20, v230, v231
    v_max_f32 v20, v20, v21
    v_sub_f32 v16, v16, v20
    v_sub_f32 v17, v17, v20
    v_sub_f32 v18, v18, v20
    v_sub_f32 v19, v19, v20
    v_exp_f32 v16, v16
    v_exp_f32 v17, v17
    v_exp_f32 v18, v18
    v_exp_f32 v19, v19
    v_cvt_pk_bf16_f32 v22, v16, v17
    v_cvt_pk_bf16_f32 v23, v18, v19
    ds_write_b64 v28, v[22:23]
    v_add_f32 v31, v16, v17
    v_add_f32 v240, v18, v19
    v_add_f32 v31, v31, v240
    v_mov_b32 v240, v31
    s_nop 1
    v_permlane32_swap_b32 v31, v240
    v_add_f32 v31, v31, v240
    v_mov_b32 v240, v31
    s_nop 1
    v_permlane16_swap_b32 v31, v240
    v_add_f32 v31, v31, v240
    s_mov_b64 exec, 0xffff
    ds_write_b32 v26, v31 offset:512
    s_mov_b64 exec, -1
    s_waitcnt lgkmcnt(0)
    s_barrier
    s_cmp_lg_u32 s3, 7
    s_cbranch_scc1 L_A_nols
    ds_read_b128 v[224:227], v27 offset:512
    ds_read_b128 v[228:231], v27 offset:528
L_A_nols:
    ds_read_b128 v[160:163], v29 offset:0
    ds_read_b128 v[164:167], v29 offset:1024
    ds_read_b128 v[168:171], v29 offset:2048
    ds_read_b128 v[172:175], v29 offset:3072
    s_cmp_lg_u32 s3, 7
    s_cbranch_scc1 L_A_nohm
    s_waitcnt lgkmcnt(4)
    v_add_f32 v224, v224, v228
    v_add_f32 v225, v225, v229
    v_add_f32 v226, v226, v230
    v_add_f32 v227, v227, v231
    v_add_f32 v224, v224, v225
    v_add_f32 v226, v226, v227
    v_add_f32 v225, v224, v226
    v_mov_b32 v224, v20
    v_mov_b32 v226, 0
    v_mov_b32 v227, s6
    s_mov_b64 exec, 0xffff
    buffer_store_dwordx4 v[224:227], v30, s[8:11], s49 offen sc1
    s_mov_b64 exec, -1
L_A_nohm:
    s_waitcnt lgkmcnt(3)
    v_mfma_f32_16x16x32_bf16 v[32:35], v[96:99], v[160:163], 0
    s_waitcnt lgkmcnt(2)
    v_mfma_f32_16x16x32_bf16 v[32:35], v[100:103], v[164:167], v[32:35]
    s_waitcnt lgkmcnt(1)
    v_mfma_f32_16x16x32_bf16 v[32:35], v[104:107], v[168:171], v[32:35]
    s_waitcnt lgkmcnt(0)
    v_mfma_f32_16x16x32_bf16 v[32:35], v[108:111], v[172:175], v[32:35]
    v_mfma_f32_16x16x32_bf16 v[36:39], v[112:115], v[160:163], 0
    v_mfma_f32_16x16x32_bf16 v[36:39], v[116:119], v[164:167], v[36:39]
    v_mfma_f32_16x16x32_bf16 v[36:39], v[120:123], v[168:171], v[36:39]
    v_mfma_f32_16x16x32_bf16 v[36:39], v[124:127], v[172:175], v[36:39]
    s_nop 3
    v_cvt_pk_bf16_f32 v48, v32, v33
    v_cvt_pk_bf16_f32 v49, v34, v35
    ds_write_b64 v15, v[48:49] offset:0
    v_mfma_f32_16x16x32_bf16 v[40:43], v[128:131], v[160:163], 0
    v_mfma_f32_16x16x32_bf16 v[40:43], v[132:135], v[164:167], v[40:43]
    v_mfma_f32_16x16x32_bf16 v[40:43], v[136:139], v[168:171], v[40:43]
    v_mfma_f32_16x16x32_bf16 v[40:43], v[140:143], v[172:175], v[40:43]
    v_cvt_pk_bf16_f32 v50, v36, v37
    v_cvt_pk_bf16_f32 v51, v38, v39
    ds_write_b64 v15, v[50:51] offset:32
    v_mfma_f32_16x16x32_bf16 v[44:47], v[144:147], v[160:163], 0
    v_mfma_f32_16x16x32_bf16 v[44:47], v[148:151], v[164:167], v[44:47]
    v_mfma_f32_16x16x32_bf16 v[44:47], v[152:155], v[168:171], v[44:47]
    v_mfma_f32_16x16x32_bf16 v[44:47], v[156:159], v[172:175], v[44:47]
    s_nop 0
    v_cvt_pk_bf16_f32 v52, v40, v41
    v_cvt_pk_bf16_f32 v53, v42, v43
    ds_write_b64 v15, v[52:53] offset:64
    s_nop 3
    v_cvt_pk_bf16_f32 v54, v44, v45
    v_cvt_pk_bf16_f32 v55, v46, v47
    ds_write_b64 v15, v[54:55] offset:96
    s_waitcnt lgkmcnt(0)
    ds_read_b128 v[56:59], v24
    ds_read_b128 v[60:63], v24 offset:1152
    s_waitcnt lgkmcnt(1)
    v_min_u32 v56, 0xfffffffe, v56
    buffer_store_dwordx4 v[56:59], v25, s[8:11], s50 offen sc1
    s_waitcnt lgkmcnt(0)
    v_min_u32 v60, 0xfffffffe, v60
    buffer_store_dwordx4 v[60:63], v25, s[8:11], s51 offen sc1
    s_endpgm
L_roleF:
    s_sub_u32 s36, s5, 24
    s_lshr_b32 s36, s36, 1
    s_lshl_b32 s36, s36, 3
    s_add_u32 s46, s36, s4
    s_cmp_ge_u32 s46, 27
    s_cbranch_scc1 L_end
    s_lshl_b32 s47, s46, 1
    s_and_b32 s36, s5, 1
    s_add_u32 s47, s47, s36
    s_load_dwordx2 s[20:21], s[0:1], 56
    s_load_dwordx2 s[24:25], s[0:1], 64
    s_load_dwordx2 s[28:29], s[0:1], 72
    s_mov_b32 s22, 2211840
    s_mov_b32 s23, 0x20000
    s_mov_b32 s26, 2211840
    s_mov_b32 s27, 0x20000
    s_mov_b32 s30, 2211840
    s_mov_b32 s31, 0x20000
    v_lshrrev_b32 v13, 2, v0
    v_mul_u32_u24 v13, 0xd80, v13
    v_and_b32 v10, 3, v0
    v_lshl_add_u32 v13, v10, 4, v13
    s_movk_i32 s38, 205
    v_add_u32 v10, 0, v0
    v_mul_u32_u24 v11, s38, v10
    v_lshrrev_b32 v11, 11, v11
    v_mul_u32_u24 v12, 10, v11
    v_sub_u32 v10, v10, v12
    v_mul_u32_u24 v11, 0x500, v11
    v_lshl_add_u32 v16, v10, 4, v11
    v_add_u32 v10, 64, v0
    v_mul_u32_u24 v11, s38, v10
    v_lshrrev_b32 v11, 11, v11
    v_mul_u32_u24 v12, 10, v11
    v_sub_u32 v10, v10, v12
    v_mul_u32_u24 v11, 0x500, v11
    v_lshl_add_u32 v17, v10, 4, v11
    v_add_u32 v10, 128, v0
    v_mul_u32_u24 v11, s38, v10
    v_lshrrev_b32 v11, 11, v11
    v_mul_u32_u24 v12, 10, v11
    v_sub_u32 v10, v10, v12
    v_mul_u32_u24 v11, 0x500, v11
    v_lshl_add_u32 v18, v10, 4, v11
    v_add_u32 v10, 192, v0
    v_mul_u32_u24 v11, s38, v10
    v_lshrrev_b32 v11, 11, v11
    v_mul_u32_u24 v12, 10, v11
    v_sub_u32 v10, v10, v12
    v_mul_u32_u24 v11, 0x500, v11
    v_lshl_add_u32 v19, v10, 4, v11
    v_add_u32 v10, 256, v0
    v_mul_u32_u24 v11, s38, v10
    v_lshrrev_b32 v11, 11, v11
    v_mul_u32_u24 v12, 10, v11
    v_sub_u32 v10, v10, v12
    v_mul_u32_u24 v11, 0x500, v11
    v_lshl_add_u32 v20, v10, 4, v11
    s_mul_i32 s37, s3, 16*3456
    s_lshl_b32 s39, s47, 6
    s_add_u32 s37, s37, s39
    s_lshl_b32 s39, s3, 10
    s_waitcnt lgkmcnt(0)
    s_barrier
    s_mov_b32 m0, s39
    s_nop 0
    buffer_load_dwordx4 v13, s[20:23], s37 offen nt lds
    s_add_u32 m0, s39, 40960
    s_nop 0
    buffer_load_dwordx4 v13, s[24:27], s37 offen nt lds
    s_add_u32 s37, s37, 442368
    s_add_u32 s39, s39, 8192
    s_mov_b32 m0, s39
    s_nop 0
    buffer_load_dwordx4 v13, s[20:23], s37 offen nt lds
    s_waitcnt vmcnt(2)
    s_add_u32 m0, s39, 40960
    s_nop 0
    buffer_load_dwordx4 v13, s[24:27], s37 offen nt lds
    s_waitcnt vmcnt(2)
    s_add_u32 s37, s37, 442368
    s_add_u32 s39, s39, 8192
    s_mov_b32 m0, s39
    s_nop 0
    buffer_load_dwordx4 v13, s[20:23], s37 offen nt lds
    s_waitcnt vmcnt(2)
    s_add_u32 m0, s39, 40960
    s_nop 0
    buffer_load_dwordx4 v13, s[24:27], s37 offen nt lds
    s_waitcnt vmcnt(2)
    s_add_u32 s37, s37, 442368
    s_add_u32 s39, s39, 8192
    s_mov_b32 m0, s39
    s_nop 0
    buffer_load_dwordx4 v13, s[20:23], s37 offen nt lds
    s_waitcnt vmcnt(2)
    s_add_u32 m0, s39, 40960
    s_nop 0
    buffer_load_dwordx4 v13, s[24:27], s37 offen nt lds
    s_waitcnt vmcnt(2)
    s_add_u32 s37, s37, 442368
    s_add_u32 s39, s39, 8192
    s_mov_b32 m0, s39
    s_nop 0
    buffer_load_dwordx4 v13, s[20:23], s37 offen nt lds
    s_waitcnt vmcnt(2)
    s_add_u32 m0, s39, 40960
    s_nop 0
    buffer_load_dwordx4 v13, s[24:27], s37 offen nt lds
    s_waitcnt vmcnt(2)
    s_mul_i32 s37, s47, 32*1280
    s_mul_i32 s39, s3, 160
    s_add_u32 s37, s37, s39
    s_mul_i32 s39, s3, 5120
    s_add_u32 s39, s39, 81920
    s_mov_b32 m0, s39
    s_nop 0
    buffer_load_dwordx4 v16, s[28:31], s37 offen nt lds
    s_waitcnt vmcnt(2)
    s_add_u32 s39, s39, 1024
    s_mov_b32 m0, s39
    s_nop 0
    buffer_load_dwordx4 v17, s[28:31], s37 offen nt lds
    s_waitcnt vmcnt(2)
    s_add_u32 s39, s39, 1024
    s_mov_b32 m0, s39
    s_nop 0
    buffer_load_dwordx4 v18, s[28:31], s37 offen nt lds
    s_waitcnt vmcnt(2)
    s_add_u32 s39, s39, 1024
    s_mov_b32 m0, s39
    s_nop 0
    buffer_load_dwordx4 v19, s[28:31], s37 offen nt lds
    s_waitcnt vmcnt(2)
    s_add_u32 s39, s39, 1024
    s_mov_b32 m0, s39
    s_nop 0
    buffer_load_dwordx4 v20, s[28:31], s37 offen nt lds
    s_waitcnt vmcnt(2)
    s_lshl_b32 s37, s3, 6
    v_add_u32 v13, s37, v0
    v_lshlrev_b32 v13, 3, v13
    buffer_load_dwordx2 v[14:15], v13, s[12:15], 0 offen
    v_lshrrev_b32 v10, 2, v1
    v_lshl_add_u32 v10, v2, 3, v10
    v_lshlrev_b32 v16, 6, v10
    v_and_b32 v11, 3, v1
    v_lshl_add_u32 v16, v11, 3, v16
    s_lshr_b32 s37, s3, 2
    s_mul_i32 s37, s37, 320*64
    s_and_b32 s39, s3, 1
    s_lshl_b32 s39, s39, 5
    s_add_u32 s37, s37, s39
    s_bfe_u32 s39, s3, 0x10001
    s_mul_i32 s39, s39, 40960
    s_add_u32 s37, s37, s39
    v_add_u32 v16, s37, v16
    v_mul_u32_u24 v17, 160, v10
    v_lshl_add_u32 v17, v11, 3, v17
    s_mul_i32 s37, s3, 5120
    s_add_u32 s37, s37, 81920
    v_add_u32 v17, s37, v17
    s_waitcnt vmcnt(0)
    s_barrier
    ds_read_b64_tr_b16 v[20:21], v16 offset:0
    ds_read_b64_tr_b16 v[22:23], v16 offset:256
    ds_read_b64_tr_b16 v[24:25], v16 offset:2048
    ds_read_b64_tr_b16 v[26:27], v16 offset:2304
    ds_read_b64_tr_b16 v[28:29], v16 offset:4096
    ds_read_b64_tr_b16 v[30:31], v16 offset:4352
    ds_read_b64_tr_b16 v[32:33], v16 offset:6144
    ds_read_b64_tr_b16 v[34:35], v16 offset:6400
    ds_read_b64_tr_b16 v[36:37], v16 offset:8192
    ds_read_b64_tr_b16 v[38:39], v16 offset:8448
    ds_read_b64_tr_b16 v[40:41], v16 offset:10240
    ds_read_b64_tr_b16 v[42:43], v16 offset:10496
    ds_read_b64_tr_b16 v[44:45], v16 offset:12288
    ds_read_b64_tr_b16 v[46:47], v16 offset:12544
    ds_read_b64_tr_b16 v[48:49], v16 offset:14336
    ds_read_b64_tr_b16 v[50:51], v16 offset:14592
    ds_read_b64_tr_b16 v[52:53], v16 offset:16384
    ds_read_b64_tr_b16 v[54:55], v16 offset:16640
    ds_read_b64_tr_b16 v[56:57], v16 offset:18432
    ds_read_b64_tr_b16 v[58:59], v16 offset:18688
    ds_read_b64_tr_b16 v[60:61], v17 offset:0
    ds_read_b64_tr_b16 v[62:63], v17 offset:640
    ds_read_b64_tr_b16 v[64:65], v17 offset:32
    ds_read_b64_tr_b16 v[66:67], v17 offset:672
    ds_read_b64_tr_b16 v[68:69], v17 offset:64
    ds_read_b64_tr_b16 v[70:71], v17 offset:704
    ds_read_b64_tr_b16 v[72:73], v17 offset:96
    ds_read_b64_tr_b16 v[74:75], v17 offset:736
    ds_read_b64_tr_b16 v[76:77], v17 offset:128
    ds_read_b64_tr_b16 v[78:79], v17 offset:768
    s_mov_b32 s37, 0x3f803f80
    v_mov_b32 v80, s37
    v_mov_b32 v81, s37
    v_mov_b32 v82, s37
    v_mov_b32 v83, s37
    v_mov_b32 v84, s37
    v_mov_b32 v85, s37
    v_mov_b32 v86, s37
    v_mov_b32 v87, s37
    v_mov_b32 v88, s37
    v_mov_b32 v89, s37
    v_mov_b32 v90, s37
    v_mov_b32 v91, s37
    v_mov_b32 v92, s37
    v_mov_b32 v93, s37
    v_mov_b32 v94, s37
    v_mov_b32 v95, s37
    v_mov_b32 v96, s37
    v_mov_b32 v97, s37
    v_mov_b32 v98, s37
    v_mov_b32 v99, s37
    v_mov_b32 v100, s37
    v_mov_b32 v101, s37
    v_mov_b32 v102, s37
    v_mov_b32 v103, s37
    v_mov_b32 v104, s37
    v_mov_b32 v105, s37
    v_mov_b32 v106, s37
    v_mov_b32 v107, s37
    v_mov_b32 v108, s37
    v_mov_b32 v109, s37
    v_mov_b32 v110, s37
    v_mov_b32 v111, s37
    v_mov_b32 v112, s37
    v_mov_b32 v113, s37
    v_mov_b32 v114, s37
    v_mov_b32 v115, s37
    v_mov_b32 v116, s37
    v_mov_b32 v117, s37
    v_mov_b32 v118, s37
    v_mov_b32 v119, s37
    s_lshr_b32 s37, s3, 2
    s_mul_i32 s37, s37, 640
    s_add_u32 s37, s37, 122880
    v_add_u32 v18, s37, v5
    v_mov_b32 v160, 0x00003f80
    v_mov_b32 v161, 0x3f800000
    v_lshlrev_b32 v156, 16, v14
    v_and_b32 v157, 0xffff0000, v14
    v_lshlrev_b32 v158, 16, v15
    v_and_b32 v159, 0xffff0000, v15
    s_lshl_b32 s39, s3, 3
    s_add_u32 s39, s39, 124160
    v_mov_b32 v10, s39
    v_lshlrev_b32 v19, 1, v13
    s_cmp_eq_u32 s3, 2
    s_cselect_b32 s50, 0, -1
    v_subrev_u32 v11, 512, v19
    s_not_b32 s51, s50
    s_mov_b32 s54, 0
    s_mov_b32 s55, s51
    v_cndmask_b32 v19, v19, v11, s[54:55]
    v_add_u32 v13, 122880, v13
    s_mul_i32 s52, s4, 0x5000
    s_add_u32 s52, s52, 163840
    s_lshl_b32 s39, s3, 6
    s_add_u32 s39, s39, 124224
    v_add_u32 v164, s39, v5
    v_lshlrev_b32 v165, 5, v2
    v_add_u32 v165, 124224, v165
    s_mul_i32 s39, s3, 160
    s_add_u32 s39, s39, 124736
    v_lshlrev_b32 v167, 3, v2
    v_add_u32 v167, s39, v167
    v_add_u32 v168, s39, v6
    v_lshrrev_b32 v166, 1, v0
    v_lshlrev_b32 v166, 11, v166
    v_and_b32 v11, 1, v0
    v_lshl_add_u32 v166, v11, 4, v166
    s_mul_i32 s53, s3, 5*2048
    s_lshl_b32 s39, s47, 5
    s_add_u32 s53, s53, s39
    s_add_u32 s53, s53, 360448
    s_cmp_lg_u32 s3, 0
    s_cbranch_scc1 L_F_nohint
    s_and_b32 s37, s47, 7
    s_mul_i32 s37, s37, 2560
    s_lshr_b32 s39, s47, 2
    s_mul_i32 s39, s39, 160
    s_add_u32 s37, s37, s39
    s_add_u32 s37, s37, s52
    s_mov_b64 exec, 1
    s_mov_b32 s48, 0
L_poll11:
    buffer_load_dwordx4 v[120:123], v4, s[8:11], s37 offen sc1
    s_waitcnt vmcnt(0)
    v_cmp_ne_u32 vcc, s6, v123
    s_add_u32 s48, s48, 1
    s_cmp_ge_u32 s48, 262144
    s_cbranch_scc1 L_polldone11
    s_cmp_lg_u64 vcc, 0
    s_cbranch_scc0 L_polldone11
    s_sleep 2
    s_branch L_poll11
L_polldone11:
    s_mov_b64 exec, -1
L_F_nohint:
    s_barrier
    s_cmp_ge_u32 s3, 3
    s_cbranch_scc1 L_F_nosum
    s_add_u32 s56, s52, 0
    s_add_u32 s57, s52, 2560
    s_add_u32 s58, s52, 5120
    s_add_u32 s59, s52, 7680
    s_add_u32 s36, s52, 10240
    s_add_u32 s37, s52, 12800
    s_add_u32 s38, s52, 15360
    s_add_u32 s39, s52, 17920
    s_mov_b32 s48, 0
L_poll12:
    buffer_load_dwordx4 v[120:123], v19, s[8:11], s56 offen sc1
    buffer_load_dwordx4 v[124:127], v19, s[8:11], s57 offen sc1
    buffer_load_dwordx4 v[128:131], v19, s[8:11], s58 offen sc1
    buffer_load_dwordx4 v[132:135], v19, s[8:11], s59 offen sc1
    buffer_load_dwordx4 v[136:139], v19, s[8:11], s36 offen sc1
    buffer_load_dwordx4 v[140:143], v19, s[8:11], s37 offen sc1
    buffer_load_dwordx4 v[144:147], v19, s[8:11], s38 offen sc1
    buffer_load_dwordx4 v[148:151], v19, s[8:11], s39 offen sc1
    s_waitcnt vmcnt(0)
    v_xor_b32 v8, s6, v123
    v_xor_b32 v9, s6, v127
    v_or_b32 v8, v8, v9
    v_xor_b32 v9, s6, v131
    v_or_b32 v8, v8, v9
    v_xor_b32 v9, s6, v135
    v_or_b32 v8, v8, v9
    v_xor_b32 v9, s6, v139
    v_or_b32 v8, v8, v9
    v_xor_b32 v9, s6, v143
    v_or_b32 v8, v8, v9
    v_xor_b32 v9, s6, v147
    v_or_b32 v8, v8, v9
    v_xor_b32 v9, s6, v151
    v_or_b32 v8, v8, v9
    v_cmp_ne_u32 vcc, 0, v8
    s_add_u32 s48, s48, 1
    s_cmp_ge_u32 s48, 262144
    s_cbranch_scc1 L_polldone12
    s_cmp_lg_u64 vcc, 0
    s_cbranch_scc1 L_poll12
L_polldone12:
    v_dot2_f32_bf16 v152, v120, v160, v156
    v_dot2_f32_bf16 v153, v120, v161, v157
    v_dot2_f32_bf16 v154, v121, v160, v158
    v_dot2_f32_bf16 v155, v121, v161, v159
    v_dot2_f32_bf16 v152, v124, v160, v152
    v_dot2_f32_bf16 v153, v124, v161, v153
    v_dot2_f32_bf16 v154, v125, v160, v154
    v_dot2_f32_bf16 v155, v125, v161, v155
    v_dot2_f32_bf16 v152, v128, v160, v152
    v_dot2_f32_bf16 v153, v128, v161, v153
    v_dot2_f32_bf16 v154, v129, v160, v154
    v_dot2_f32_bf16 v155, v129, v161, v155
    v_dot2_f32_bf16 v152, v132, v160, v152
    v_dot2_f32_bf16 v153, v132, v161, v153
    v_dot2_f32_bf16 v154, v133, v160, v154
    v_dot2_f32_bf16 v155, v133, v161, v155
    v_dot2_f32_bf16 v152, v136, v160, v152
    v_dot2_f32_bf16 v153, v136, v161, v153
    v_dot2_f32_bf16 v154, v137, v160, v154
    v_dot2_f32_bf16 v155, v137, v161, v155
    v_dot2_f32_bf16 v152, v140, v160, v152
    v_dot2_f32_bf16 v153, v140, v161, v153
    v_dot2_f32_bf16 v154, v141, v160, v154
    v_dot2_f32_bf16 v155, v141, v161, v155
    v_dot2_f32_bf16 v152, v144, v160, v152
    v_dot2_f32_bf16 v153, v144, v161, v153
    v_dot2_f32_bf16 v154, v145, v160, v154
    v_dot2_f32_bf16 v155, v145, v161, v155
    v_dot2_f32_bf16 v152, v148, v160, v152
    v_dot2_f32_bf16 v153, v148, v161, v153
    v_dot2_f32_bf16 v154, v149, v160, v154
    v_dot2_f32_bf16 v155, v149, v161, v155
    s_nop 0
    v_cvt_pk_bf16_f32 v156, v152, v153
    s_nop 0
    v_cvt_pk_bf16_f32 v157, v154, v155
    s_mov_b32 exec_hi, s50
    ds_write_b64 v13, v[156:157]
    s_mov_b64 exec, -1
    v_add_f32 v162, v152, v153
    v_add_f32 v163, v154, v155
    v_add_f32 v162, v162, v163
    v_mul_f32 v163, v152, v152
    v_fmac_f32 v163, v153, v153
    v_fmac_f32 v163, v154, v154
    v_fmac_f32 v163, v155, v155
    v_cndmask_b32 v162, v162, v4, s[54:55]
    v_cndmask_b32 v163, v163, v4, s[54:55]
    s_nop 0
    v_add_f32_dpp v162, v162, v162 row_shr:1 row_mask:0xf bank_mask:0xf bound_ctrl:0
    v_add_f32_dpp v163, v163, v163 row_shr:1 row_mask:0xf bank_mask:0xf bound_ctrl:0
    s_nop 0
    v_add_f32_dpp v162, v162, v162 row_shr:2 row_mask:0xf bank_mask:0xf bound_ctrl:0
    v_add_f32_dpp v163, v163, v163 row_shr:2 row_mask:0xf bank_mask:0xf bound_ctrl:0
    s_nop 0
    v_add_f32_dpp v162, v162, v162 row_shr:4 row_mask:0xf bank_mask:0xf bound_ctrl:0
    v_add_f32_dpp v163, v163, v163 row_shr:4 row_mask:0xf bank_mask:0xf bound_ctrl:0
    s_nop 0
    v_add_f32_dpp v162, v162, v162 row_shr:8 row_mask:0xf bank_mask:0xf bound_ctrl:0
    v_add_f32_dpp v163, v163, v163 row_shr:8 row_mask:0xf bank_mask:0xf bound_ctrl:0
    s_nop 0
    v_add_f32_dpp v162, v162, v162 row_bcast:15 row_mask:0xa bank_mask:0xf
    v_add_f32_dpp v163, v163, v163 row_bcast:15 row_mask:0xa bank_mask:0xf
    s_nop 0
    v_add_f32_dpp v162, v162, v162 row_bcast:31 row_mask:0xc bank_mask:0xf
    v_add_f32_dpp v163, v163, v163 row_bcast:31 row_mask:0xc bank_mask:0xf
    s_mov_b32 exec_lo, 0
    s_mov_b32 exec_hi, 0x80000000
    ds_write_b64 v10, v[162:163]
    s_mov_b64 exec, -1
L_F_nosum:
    s_waitcnt lgkmcnt(0)
    s_barrier
    v_mov_b32 v10, 124160
    s_mov_b32 exec_lo, 0x55555555
    s_mov_b32 exec_hi, 0x55555555
    ds_read_b128 v[80:83], v18 offset:0
    ds_read_b128 v[84:87], v18 offset:64
    ds_read_b128 v[88:91], v18 offset:128
    ds_read_b128 v[92:95], v18 offset:192
    ds_read_b128 v[96:99], v18 offset:256
    ds_read_b128 v[100:103], v18 offset:320
    ds_read_b128 v[104:107], v18 offset:384
    ds_read_b128 v[108:111], v18 offset:448
    ds_read_b128 v[112:115], v18 offset:512
    ds_read_b128 v[116:119], v18 offset:576
    s_mov_b64 exec, -1
    ds_read_b128 v[120:123], v10
    ds_read_b64 v[124:125], v10 offset:16
    s_waitcnt lgkmcnt(11)
    v_mfma_f32_16x16x32_bf16 v[128:131], v[20:23], v[80:83], 0
    s_waitcnt lgkmcnt(10)
    v_mfma_f32_16x16x32_bf16 v[128:131], v[24:27], v[84:87], v[128:131]
    s_waitcnt lgkmcnt(9)
    v_mfma_f32_16x16x32_bf16 v[128:131], v[28:31], v[88:91], v[128:131]
    s_waitcnt lgkmcnt(8)
    v_mfma_f32_16x16x32_bf16 v[128:131], v[32:35], v[92:95], v[128:131]
    s_waitcnt lgkmcnt(7)
    v_mfma_f32_16x16x32_bf16 v[128:131], v[36:39], v[96:99], v[128:131]
    s_waitcnt lgkmcnt(6)
    v_mfma_f32_16x16x32_bf16 v[128:131], v[40:43], v[100:103], v[128:131]
    s_waitcnt lgkmcnt(5)
    v_mfma_f32_16x16x32_bf16 v[128:131], v[44:47], v[104:107], v[128:131]
    s_waitcnt lgkmcnt(4)
    v_mfma_f32_16x16x32_bf16 v[128:131], v[48:51], v[108:111], v[128:131]
    s_waitcnt lgkmcnt(3)
    v_mfma_f32_16x16x32_bf16 v[128:131], v[52:55], v[112:115], v[128:131]
    s_waitcnt lgkmcnt(2)
    v_mfma_f32_16x16x32_bf16 v[128:131], v[56:59], v[116:119], v[128:131]
    s_waitcnt lgkmcnt(0)
    v_add_f32 v120, v120, v122
    v_add_f32 v121, v121, v123
    v_add_f32 v120, v120, v124
    v_add_f32 v121, v121, v125
    s_mov_b32 s37, 986500301
    v_mul_f32 v120, s37, v120
    v_mul_f32 v121, s37, v121
    v_fma_f32 v121, -v120, v120, v121
    v_add_f32 v121, 925353388, v121
    v_rsq_f32 v121, v121
    v_sub_f32 v120, 0, v120
    s_nop 1
    v_fmac_f32_dpp v128, v128, v120 quad_perm:[1,1,3,3] row_mask:0xf bank_mask:0xf
    v_fmac_f32_dpp v129, v129, v120 quad_perm:[1,1,3,3] row_mask:0xf bank_mask:0xf
    v_fmac_f32_dpp v130, v130, v120 quad_perm:[1,1,3,3] row_mask:0xf bank_mask:0xf
    v_fmac_f32_dpp v131, v131, v120 quad_perm:[1,1,3,3] row_mask:0xf bank_mask:0xf
    s_mov_b64 exec, s[40:41]
    ds_write_b128 v164, v[128:131]
    s_mov_b64 exec, -1
    v_mul_f32 v121, v121, v121
    s_waitcnt lgkmcnt(0)
    s_barrier
    ds_read_b128 v[132:135], v165 offset:0
    ds_read_b128 v[136:139], v165 offset:16
    ds_read_b128 v[140:143], v165 offset:256
    ds_read_b128 v[144:147], v165 offset:272
    ds_read_b128 v[148:151], v165 offset:128
    ds_read_b128 v[152:155], v165 offset:144
    ds_read_b128 v[156:159], v165 offset:384
    ds_read_b128 v[160:163], v165 offset:400
    s_waitcnt lgkmcnt(4)
    v_add_f32 v132, v132, v140
    v_add_f32 v133, v133, v141
    v_add_f32 v134, v134, v142
    v_add_f32 v135, v135, v143
    v_add_f32 v136, v136, v144
    v_add_f32 v137, v137, v145
    v_add_f32 v138, v138, v146
    v_add_f32 v139, v139, v147
    v_max_f32 v132, 0, v132
    v_max_f32 v133, 0, v133
    v_max_f32 v134, 0, v134
    v_max_f32 v135, 0, v135
    v_max_f32 v136, 0, v136
    v_max_f32 v137, 0, v137
    v_max_f32 v138, 0, v138
    v_max_f32 v139, 0, v139
    v_mul_f32 v132, v132, v121
    v_mul_f32 v133, v133, v121
    v_mul_f32 v134, v134, v121
    v_mul_f32 v135, v135, v121
    v_mul_f32 v136, v136, v121
    v_mul_f32 v137, v137, v121
    v_mul_f32 v138, v138, v121
    v_mul_f32 v139, v139, v121
    s_waitcnt lgkmcnt(0)
    v_add_f32 v148, v148, v156
    v_add_f32 v149, v149, v157
    v_add_f32 v150, v150, v158
    v_add_f32 v151, v151, v159
    v_add_f32 v152, v152, v160
    v_add_f32 v153, v153, v161
    v_add_f32 v154, v154, v162
    v_add_f32 v155, v155, v163
    v_mul_f32 v132, v132, v148
    v_mul_f32 v133, v133, v149
    v_mul_f32 v134, v134, v150
    v_mul_f32 v135, v135, v151
    v_mul_f32 v136, v136, v152
    v_mul_f32 v137, v137, v153
    v_mul_f32 v138, v138, v154
    v_mul_f32 v139, v139, v155
    v_cvt_pk_bf16_f32 v140, v132, v133
    v_cvt_pk_bf16_f32 v141, v134, v135
    v_cvt_pk_bf16_f32 v142, v136, v137
    v_cvt_pk_bf16_f32 v143, v138, v139
    s_nop 1
    v_mfma_f32_16x16x32_bf16 v[20:23], v[60:63], v[140:143], 0
    v_mfma_f32_16x16x32_bf16 v[24:27], v[64:67], v[140:143], 0
    v_mfma_f32_16x16x32_bf16 v[28:31], v[68:71], v[140:143], 0
    v_mfma_f32_16x16x32_bf16 v[32:35], v[72:75], v[140:143], 0
    v_mfma_f32_16x16x32_bf16 v[36:39], v[76:79], v[140:143], 0
    s_mov_b64 exec, s[40:41]
    s_nop 2
    v_cvt_pk_bf16_f32 v40, v20, v21
    v_cvt_pk_bf16_f32 v41, v22, v23
    ds_write_b64 v167, v[40:41] offset:0
    v_cvt_pk_bf16_f32 v42, v24, v25
    v_cvt_pk_bf16_f32 v43, v26, v27
    ds_write_b64 v167, v[42:43] offset:32
    v_cvt_pk_bf16_f32 v44, v28, v29
    v_cvt_pk_bf16_f32 v45, v30, v31
    ds_write_b64 v167, v[44:45] offset:64
    v_cvt_pk_bf16_f32 v46, v32, v33
    v_cvt_pk_bf16_f32 v47, v34, v35
    ds_write_b64 v167, v[46:47] offset:96
    v_cvt_pk_bf16_f32 v48, v36, v37
    v_cvt_pk_bf16_f32 v49, v38, v39
    ds_write_b64 v167, v[48:49] offset:128
    s_mov_b64 exec, 0x3ff
    s_waitcnt lgkmcnt(0)
    ds_read_b128 v[20:23], v168
    s_waitcnt lgkmcnt(0)
    v_min_u32 v20, 0xfffffffe, v20
    v_min_u32 v22, 0xfffffffe, v22
    buffer_store_dwordx4 v[20:23], v166, s[8:11], s53 offen sc1
    s_mov_b64 exec, -1
L_end:
    s_endpgm
L_codeend:
.section .rodata,"a"
.p2align 6
.amdhsa_kernel sequential_preLN__compressed_kv_cla__glu_gated_reglu__decode_kernel
  .amdhsa_next_free_vgpr 256
  .amdhsa_next_free_sgpr 102
  .amdhsa_accum_offset 256
  .amdhsa_group_segment_fixed_size 0
  .amdhsa_kernarg_size 104
  .amdhsa_user_sgpr_count 2
  .amdhsa_user_sgpr_kernarg_segment_ptr 1
  .amdhsa_system_sgpr_workgroup_id_x 1
.end_amdhsa_kernel
```
